```python
import torch

def _softmax(x, axis=-1):
    return torch.softmax(x, dim=axis)
def _gelu(x):
    return torch.nn.functional.gelu(x, approximate="tanh")
def _silu(x):
    return torch.nn.functional.silu(x)
def _sigmoid(x):
    return torch.sigmoid(x)
def _layernorm(x, axis=-1, eps=1e-5):
    m = x.mean(dim=axis, keepdim=True)
    v = x.var(dim=axis, keepdim=True, unbiased=False)
    return (x - m) / torch.sqrt(v + eps)
def _scatter_add(tgt, idx, src, axis=0):
    return tgt.clone().index_add_(axis, idx, src)
def _segment_sum(src, seg, n):
    out = torch.zeros((n,) + src.shape[1:], dtype=src.dtype)
    return out.index_add_(0, seg, src)
def _pad(x, pw):
    flat = tuple(v for pair in reversed(pw) for v in pair)
    return torch.nn.functional.pad(x, flat)

kernel_name = 'standalone__deep_cross_wide_deep__recsys'

def setup_inputs():

    _w = (lambda a: (lambda t: t.to(torch.bfloat16) if t.is_floating_point() else t)(torch.as_tensor(a)))
    B, F, D = 4096, 26, 128
    V, Nd = min(1000, 100000), 13
    Din = F * D
    H = 4 * D
    return {
        "idx": _w((lambda lo, hi, *s: torch.randint(lo, hi, s))(0, V, B, F).to(torch.int64)),
        "table": _w((lambda *s: torch.randn(*s, dtype=torch.bfloat16) * 1.6)(V, D) * 0.05),
        "x_wide": _w((lambda *s: torch.randn(*s, dtype=torch.bfloat16) * 1.6)(B, Nd)),
        "w_wide": _w((lambda *s: torch.randn(*s, dtype=torch.bfloat16) * 1.6)(Nd) * 0.05),
        "b_wide": _w((lambda *s: torch.randn(*s, dtype=torch.bfloat16) * 1.6)(1) * 0.01),
        "W1": _w((lambda *s: torch.randn(*s, dtype=torch.bfloat16) * 1.6)(Din, H) * (2.0 / Din) ** 0.5),
        "b1": _w((lambda *s: torch.randn(*s, dtype=torch.bfloat16) * 1.6)(H) * 0.01),
        "W2": _w((lambda *s: torch.randn(*s, dtype=torch.bfloat16) * 1.6)(H) * (1.0 / H) ** 0.5),
        "b2": _w((lambda *s: torch.randn(*s, dtype=torch.bfloat16) * 1.6)(1) * 0.01),
    }

def reference(idx, table, x_wide, w_wide, b_wide, W1, b1, W2, b2):
    emb = table[idx]
    deep_in = emb.reshape(emb.shape[0], -1)
    h = deep_in @ W1 + b1
    h = h * (lambda x, dt: x.to(dt))(h > 0, h.dtype)
    deep_logit = h @ W2 + b2
    wide_logit = x_wide @ w_wide + b_wide
    return _sigmoid(wide_logit + deep_logit)
```

```asm
; @launch grid=(256,1,1) block=(256,1,1) lds=163840
.amdgcn_target "amdgcn-amd-amdhsa--gfx950"
.text
.globl standalone__deep_cross_wide_deep__recsys_kernel
.p2align 8
.type standalone__deep_cross_wide_deep__recsys_kernel,@function
standalone__deep_cross_wide_deep__recsys_kernel:
  s_cmp_ge_u32 s2, 256
  s_cbranch_scc1 L_END
  s_load_dwordx2 s[28:29], s[0:1], 0
  s_load_dwordx2 s[32:33], s[0:1], 8
  s_load_dwordx2 s[36:37], s[0:1], 40
  s_load_dwordx4 s[16:19], s[0:1], 48
  s_load_dwordx4 s[8:11], s[0:1], 16
  s_load_dwordx2 s[12:13], s[0:1], 32
  s_load_dwordx8 s[20:27], s[0:1], 64
  v_lshrrev_b32 v242, 6, v0
  v_and_b32 v1, 63, v0
  v_readfirstlane_b32 s3, v242
  s_and_b32 s4, s2, 7
  s_lshr_b32 s5, s2, 3
  s_mov_b32 s30, 425984
  s_mov_b32 s31, 0x00020000
  s_mov_b32 s34, 256000
  s_mov_b32 s35, 0x00020000
  s_mov_b32 s38, 3407872
  s_mov_b32 s39, 0x00020000
  s_mul_i32 s43, s3, 3328
  s_add_u32 m0, s43, 131008
  s_mul_i32 s44, s5, 13312
  s_add_u32 s44, s44, s43
  v_lshlrev_b32 v243, 4, v1
  s_lshl_b32 s45, s4, 7
  v_and_b32 v244, 7, v1
  v_lshlrev_b32 v250, 8, v244
  s_lshl_b32 s51, s5, 13
  s_lshl_b32 s47, s3, 11
  s_add_u32 s51, s51, s47
  s_mul_i32 s49, s5, 26
  s_mul_i32 s50, s3, 7
  s_add_u32 s49, s49, s50
  v_min_u32 v245, 6, v1
  v_add_u32 v245, s49, v245
  v_lshrrev_b32 v251, 5, v245
  v_and_b32 v245, 31, v245
  v_lshlrev_b32 v245, 10, v245
  v_lshl_add_u32 v245, v251, 17, v245
  v_lshrrev_b32 v242, 2, v1
  v_lshlrev_b32 v8, 8, v242
  v_and_b32 v242, 3, v1
  v_lshl_add_u32 v8, v242, 4, v8
  v_add_u32 v9, 3056, v8
  v_add_u32 v10, 6112, v8
  v_add_u32 v11, 9168, v8
  s_lshl_b32 s43, s3, 4
  s_min_u32 s43, s43, 47
  s_mul_i32 s40, s43, 1040
  s_lshl_b32 s41, s43, 12
  s_waitcnt lgkmcnt(0)
  buffer_load_dword v240, v250, s[32:35], s51 offen
  buffer_load_dword v240, v245, s[36:39], s45 offen
  v_mov_b32 v251, v245
  s_mov_b32 s52, s45
  buffer_load_dwordx4 v243, s[28:31], s44 offen lds
  buffer_load_dwordx4 v243, s[28:31], s44 offen offset:1024 lds
  buffer_load_dwordx4 v243, s[28:31], s44 offen offset:2048 lds
  s_mov_b64 exec, 0xffff
  buffer_load_dwordx4 v243, s[28:31], s44 offen offset:3072 lds
  s_mov_b64 exec, -1
  s_load_dwordx4 s[64:67], s[10:11], 0
  s_load_dwordx2 s[68:69], s[10:11], 16
  s_load_dword s70, s[10:11], 24
  s_load_dword s71, s[12:13], 0
  s_load_dword s72, s[20:21], 0
  v_and_b32 v2, 48, v1
  v_lshlrev_b32 v4, 9, v2
  v_and_b32 v242, 8, v1
  v_lshl_add_u32 v4, v242, 7, v4
  v_lshl_add_u32 v4, v244, 4, v4
  s_mul_i32 s43, s3, 786432
  s_add_u32 s43, s43, s45
  v_add_u32 v4, s43, v4
  v_add_u32 v5, 4096, v4
  v_and_b32 v2, 32, v1
  s_add_u32 s49, s40, 65504
  s_add_u32 s50, s40, 0
  s_add_u32 s47, s41, 0
  s_add_u32 s48, s41, 64
  s_mov_b32 m0, s49
  s_nop 0
  buffer_load_dwordx4 v8, s[32:35], s47 offen lds
  buffer_load_dwordx4 v9, s[32:35], s47 offen offset:1040 lds
  s_mov_b32 m0, s50
  s_nop 0
  buffer_load_dwordx4 v8, s[32:35], s48 offen lds
  buffer_load_dwordx4 v9, s[32:35], s48 offen offset:1040 lds
  s_mov_b32 m0, s49
  s_nop 0
  buffer_load_dwordx4 v10, s[32:35], s47 offen offset:2080 lds
  buffer_load_dwordx4 v11, s[32:35], s47 offen offset:3120 lds
  s_mov_b32 m0, s50
  s_nop 0
  buffer_load_dwordx4 v10, s[32:35], s48 offen offset:2080 lds
  buffer_load_dwordx4 v11, s[32:35], s48 offen offset:3120 lds
  v_mov_b32 v6, 0x05040100
  v_mov_b32 v245, 0x03020706
  v_cmp_ne_u32 vcc, 0, v242
  s_mov_b32 s42, 65
  s_cmp_lt_u32 s3, 2
  v_cndmask_b32 v6, v6, v245, vcc
  s_cselect_b32 s43, 65504, 0
  v_add_u32 v3, s43, v2
  v_lshlrev_b32 v7, 1, v2
  v_add_u32 v7, s45, v7
  s_and_b32 s43, s3, 1
  s_add_u32 s43, s43, 24
  s_mul_i32 s7, s3, 6
  s_sub_u32 s7, s43, s7
  s_lshl_b32 s45, s7, 2
  s_lshl_b32 s7, s7, 17
  s_lshr_b32 s43, s3, 1
  s_lshl_b32 s43, s43, 15
  s_add_u32 s7, s7, s43
  v_and_b32 v245, 31, v1
  v_mul_u32_u24 v242, 104, v245
  s_mul_i32 s43, s3, 24
  s_add_u32 s43, s43, 131008
  v_add_u32 v242, s43, v242
  s_add_u32 s43, s3, 1
  s_and_b32 s43, s43, 3
  s_mul_i32 s44, s43, 3328
  v_add_u32 v224, s44, v242
  s_lshl_b32 s43, s43, 13
  s_add_u32 s43, s43, 65504
  v_add_u32 v12, s43, v243
  s_add_u32 s43, s3, 2
  s_and_b32 s43, s43, 3
  s_mul_i32 s44, s43, 3328
  v_add_u32 v225, s44, v242
  s_lshl_b32 s43, s43, 13
  s_add_u32 s43, s43, 98272
  v_add_u32 v13, s43, v243
  s_add_u32 s43, s3, 3
  s_and_b32 s43, s43, 3
  s_mul_i32 s44, s43, 3328
  v_add_u32 v226, s44, v242
  s_lshl_b32 s43, s43, 13
  s_add_u32 s43, s43, 131040
  v_add_u32 v14, s43, v243
  s_add_u32 s43, s3, 4
  s_and_b32 s43, s43, 3
  s_mul_i32 s44, s43, 3328
  v_add_u32 v227, s44, v242
  s_lshl_b32 s43, s3, 13
  s_add_u32 s43, s43, 65504
  v_add_u32 v15, s43, v243
  v_add_u32 v236, 0x10000, v15
  v_add_u32 v208, s45, v224
  v_add_u32 v209, s45, v225
  v_add_u32 v210, s45, v226
  v_add_u32 v211, s45, v227
  v_add_u32 v0, s40, v243
  v_add_u32 v248, 65504, v0
  s_lshl_b32 s43, s5, 7
  s_lshl_b32 s44, s3, 5
  s_add_u32 s43, s43, s44
  v_add_u32 v245, s43, v245
  v_lshlrev_b32 v239, 3, v245
  v_mov_b32 v246, 0
  v_mov_b32 v247, 0
  s_or_b32 s43, s4, s3
  s_cmp_eq_u32 s43, 0
  s_cselect_b32 s46, 1, 0
  s_cmp_eq_u32 s4, 0
  s_cselect_b32 s53, -1, 0
  s_waitcnt vmcnt(8)
  s_barrier
  ds_read2_b64 v[16:19], v224 offset0:0 offset1:1
  ds_read_b64 v[20:21], v224 offset:16
  ds_read_b32 v22, v208
  ds_read2_b64 v[24:27], v225 offset0:0 offset1:1
  ds_read_b64 v[28:29], v225 offset:16
  ds_read_b32 v30, v209
  ds_read2_b64 v[32:35], v226 offset0:0 offset1:1
  ds_read_b64 v[36:37], v226 offset:16
  ds_read_b32 v38, v210
  ds_read2_b64 v[40:43], v227 offset0:0 offset1:1
  ds_read_b64 v[44:45], v227 offset:16
  ds_read_b32 v46, v211
  s_add_u32 s49, s40, 69664
  s_add_u32 s50, s40, 4160
  s_add_u32 s47, s41, 16384
  s_add_u32 s48, s41, 16448
  s_mov_b32 m0, s49
  s_nop 0
  buffer_load_dwordx4 v8, s[32:35], s47 offen lds
  buffer_load_dwordx4 v9, s[32:35], s47 offen offset:1040 lds
  s_mov_b32 m0, s50
  s_nop 0
  buffer_load_dwordx4 v8, s[32:35], s48 offen lds
  buffer_load_dwordx4 v9, s[32:35], s48 offen offset:1040 lds
  s_waitcnt lgkmcnt(0)
  s_mov_b32 m0, s49
  s_nop 0
  buffer_load_dwordx4 v10, s[32:35], s47 offen offset:2080 lds
  v_mad_u32_u24 v16, v16, s42, v2
  v_mad_u32_u24 v24, v24, s42, v2
  v_mad_u32_u24 v32, v32, s42, v2
  v_mad_u32_u24 v40, v40, s42, v2
  buffer_load_dwordx4 v11, s[32:35], s47 offen offset:3120 lds
  v_and_b32 v16, -16, v16
  v_and_b32 v24, -16, v24
  v_and_b32 v32, -16, v32
  v_and_b32 v40, -16, v40
  s_mov_b32 m0, s50
  s_nop 0
  buffer_load_dwordx4 v10, s[32:35], s48 offen offset:2080 lds
  v_mad_u32_u24 v17, v17, s42, v2
  v_mad_u32_u24 v25, v25, s42, v2
  v_mad_u32_u24 v33, v33, s42, v2
  v_mad_u32_u24 v41, v41, s42, v2
  buffer_load_dwordx4 v11, s[32:35], s48 offen offset:3120 lds
  v_and_b32 v17, -16, v17
  v_and_b32 v25, -16, v25
  v_and_b32 v33, -16, v33
  v_and_b32 v41, -16, v41
  s_mov_b32 s6, 0
  buffer_load_dwordx4 v[64:67], v4, s[36:39], s6 offen
  v_mad_u32_u24 v18, v18, s42, v2
  v_mad_u32_u24 v26, v26, s42, v2
  v_mad_u32_u24 v34, v34, s42, v2
  v_mad_u32_u24 v42, v42, s42, v2
  buffer_load_dwordx4 v[68:71], v4, s[36:39], s6 offen offset:2048
  v_and_b32 v18, -16, v18
  v_and_b32 v26, -16, v26
  v_and_b32 v34, -16, v34
  v_and_b32 v42, -16, v42
  buffer_load_dwordx4 v[72:75], v5, s[36:39], s6 offen
  v_mad_u32_u24 v19, v19, s42, v2
  v_mad_u32_u24 v27, v27, s42, v2
  v_mad_u32_u24 v35, v35, s42, v2
  v_mad_u32_u24 v43, v43, s42, v2
  buffer_load_dwordx4 v[76:79], v5, s[36:39], s6 offen offset:2048
  v_and_b32 v19, -16, v19
  v_and_b32 v27, -16, v27
  v_and_b32 v35, -16, v35
  v_and_b32 v43, -16, v43
  s_add_u32 s49, s40, 73824
  s_add_u32 s50, s40, 8320
  s_add_u32 s47, s41, 32768
  s_add_u32 s48, s41, 32832
  s_mov_b32 m0, s49
  s_nop 0
  buffer_load_dwordx4 v8, s[32:35], s47 offen lds
  v_mad_u32_u24 v20, v20, s42, v2
  v_mad_u32_u24 v28, v28, s42, v2
  v_mad_u32_u24 v36, v36, s42, v2
  v_mad_u32_u24 v44, v44, s42, v2
  buffer_load_dwordx4 v9, s[32:35], s47 offen offset:1040 lds
  v_and_b32 v20, -16, v20
  v_and_b32 v28, -16, v28
  v_and_b32 v36, -16, v36
  v_and_b32 v44, -16, v44
  s_mov_b32 m0, s50
  s_nop 0
  buffer_load_dwordx4 v8, s[32:35], s48 offen lds
  v_mad_u32_u24 v21, v21, s42, v2
  v_mad_u32_u24 v29, v29, s42, v2
  v_mad_u32_u24 v37, v37, s42, v2
  v_mad_u32_u24 v45, v45, s42, v2
  buffer_load_dwordx4 v9, s[32:35], s48 offen offset:1040 lds
  v_and_b32 v21, -16, v21
  v_and_b32 v29, -16, v29
  v_and_b32 v37, -16, v37
  v_and_b32 v45, -16, v45
  s_mov_b32 m0, s49
  s_nop 0
  buffer_load_dwordx4 v10, s[32:35], s47 offen offset:2080 lds
  v_mad_u32_u24 v22, v22, s42, v3
  v_mad_u32_u24 v30, v30, s42, v3
  v_mad_u32_u24 v38, v38, s42, v3
  v_mad_u32_u24 v46, v46, s42, v3
  buffer_load_dwordx4 v11, s[32:35], s47 offen offset:3120 lds
  v_and_b32 v22, -16, v22
  v_and_b32 v30, -16, v30
  v_and_b32 v38, -16, v38
  v_and_b32 v46, -16, v46
  s_mov_b32 m0, s50
  s_nop 0
  buffer_load_dwordx4 v10, s[32:35], s48 offen offset:2080 lds
  buffer_load_dwordx4 v11, s[32:35], s48 offen offset:3120 lds
  s_add_u32 s49, s40, 77984
  s_add_u32 s50, s40, 12480
  s_add_u32 s47, s41, 49152
  s_add_u32 s48, s41, 49216
  s_mov_b32 m0, s49
  s_nop 0
  buffer_load_dwordx4 v8, s[32:35], s47 offen lds
  buffer_load_dwordx4 v9, s[32:35], s47 offen offset:1040 lds
  s_mov_b32 m0, s50
  s_nop 0
  buffer_load_dwordx4 v8, s[32:35], s48 offen lds
  buffer_load_dwordx4 v9, s[32:35], s48 offen offset:1040 lds
  s_mov_b32 m0, s49
  s_nop 0
  buffer_load_dwordx4 v10, s[32:35], s47 offen offset:2080 lds
  buffer_load_dwordx4 v11, s[32:35], s47 offen offset:3120 lds
  s_mov_b32 m0, s50
  s_nop 0
  buffer_load_dwordx4 v10, s[32:35], s48 offen offset:2080 lds
  buffer_load_dwordx4 v11, s[32:35], s48 offen offset:3120 lds
  s_mov_b32 s6, 131072
  buffer_load_dwordx4 v[80:83], v4, s[36:39], s6 offen
  buffer_load_dwordx4 v[84:87], v4, s[36:39], s6 offen offset:2048
  buffer_load_dwordx4 v[88:91], v5, s[36:39], s6 offen
  buffer_load_dwordx4 v[92:95], v5, s[36:39], s6 offen offset:2048
  s_mov_b32 s6, 262144
  buffer_load_dwordx4 v[96:99], v4, s[36:39], s6 offen
  buffer_load_dwordx4 v[100:103], v4, s[36:39], s6 offen offset:2048
  buffer_load_dwordx4 v[104:107], v5, s[36:39], s6 offen
  buffer_load_dwordx4 v[108:111], v5, s[36:39], s6 offen offset:2048
  s_waitcnt vmcnt(26)
  v_mov_b32_dpp v232, v64 row_ror:8 row_mask:0xf bank_mask:0xf
  v_perm_b32 v48, v232, v64, v6
  v_mov_b32_dpp v233, v65 row_ror:8 row_mask:0xf bank_mask:0xf
  v_perm_b32 v52, v233, v65, v6
  v_mov_b32_dpp v234, v66 row_ror:8 row_mask:0xf bank_mask:0xf
  v_perm_b32 v56, v234, v66, v6
  v_mov_b32_dpp v235, v67 row_ror:8 row_mask:0xf bank_mask:0xf
  v_permlane16_swap_b32 v48, v52
  v_perm_b32 v60, v235, v67, v6
  v_mov_b32_dpp v232, v68 row_ror:8 row_mask:0xf bank_mask:0xf
  v_perm_b32 v49, v232, v68, v6
  v_permlane16_swap_b32 v56, v60
  v_mov_b32_dpp v233, v69 row_ror:8 row_mask:0xf bank_mask:0xf
  v_perm_b32 v53, v233, v69, v6
  v_mov_b32_dpp v234, v70 row_ror:8 row_mask:0xf bank_mask:0xf
  v_perm_b32 v57, v234, v70, v6
  v_mov_b32_dpp v235, v71 row_ror:8 row_mask:0xf bank_mask:0xf
  v_permlane16_swap_b32 v49, v53
  v_perm_b32 v61, v235, v71, v6
  s_waitcnt vmcnt(24)
  v_mov_b32_dpp v232, v72 row_ror:8 row_mask:0xf bank_mask:0xf
  v_perm_b32 v50, v232, v72, v6
  v_permlane16_swap_b32 v57, v61
  v_mov_b32_dpp v233, v73 row_ror:8 row_mask:0xf bank_mask:0xf
  v_perm_b32 v54, v233, v73, v6
  v_mov_b32_dpp v234, v74 row_ror:8 row_mask:0xf bank_mask:0xf
  v_perm_b32 v58, v234, v74, v6
  v_mov_b32_dpp v235, v75 row_ror:8 row_mask:0xf bank_mask:0xf
  v_permlane16_swap_b32 v50, v54
  v_perm_b32 v62, v235, v75, v6
  v_mov_b32_dpp v232, v76 row_ror:8 row_mask:0xf bank_mask:0xf
  v_perm_b32 v51, v232, v76, v6
  v_permlane16_swap_b32 v58, v62
  v_mov_b32_dpp v233, v77 row_ror:8 row_mask:0xf bank_mask:0xf
  v_perm_b32 v55, v233, v77, v6
  v_mov_b32_dpp v234, v78 row_ror:8 row_mask:0xf bank_mask:0xf
  v_perm_b32 v59, v234, v78, v6
  v_mov_b32_dpp v235, v79 row_ror:8 row_mask:0xf bank_mask:0xf
  v_permlane16_swap_b32 v51, v55
  v_perm_b32 v63, v235, v79, v6
  s_nop 1
  v_permlane16_swap_b32 v59, v63
  s_waitcnt vmcnt(8)
  s_barrier
  ds_read_b128 a[96:99], v16 offset:65504
  ds_read_b128 a[100:103], v16 offset:65520
  ds_read_b128 a[104:107], v24 offset:65504
  ds_read_b128 a[108:111], v24 offset:65520
  ds_read_b128 a[112:115], v32 offset:65504
  ds_read_b128 a[116:119], v32 offset:65520
  ds_read_b128 a[120:123], v40 offset:65504
  ds_read_b128 a[124:127], v40 offset:65520
  s_waitcnt lgkmcnt(7)
  v_mfma_f32_32x32x16_bf16 a[0:15], v[48:51], a[96:99], 0
  s_mov_b32 s6, 393216
  buffer_load_dwordx4 v[112:115], v4, s[36:39], s6 offen
  v_mfma_f32_32x32x16_bf16 a[16:31], v[56:59], a[96:99], 0
  ds_read_b128 a[96:99], v17 offset:65504
  s_waitcnt lgkmcnt(7)
  v_mfma_f32_32x32x16_bf16 a[0:15], v[52:55], a[100:103], a[0:15]
  buffer_load_dword v240, v250, s[32:35], s51 offen offset:128
  v_mfma_f32_32x32x16_bf16 a[16:31], v[60:63], a[100:103], a[16:31]
  ds_read_b128 a[100:103], v17 offset:65520
  s_waitcnt lgkmcnt(7)
  v_mfma_f32_32x32x16_bf16 a[32:47], v[48:51], a[104:107], 0
  buffer_load_dwordx4 v[116:119], v4, s[36:39], s6 offen offset:2048
  global_load_dwordx4 v[208:211], v7, s[16:17]
  v_mfma_f32_32x32x16_bf16 a[48:63], v[56:59], a[104:107], 0
  ds_read_b128 a[104:107], v25 offset:65504
  s_waitcnt vmcnt(10)
  v_mov_b32_dpp v232, v80 row_ror:8 row_mask:0xf bank_mask:0xf
  v_perm_b32 v128, v232, v80, v6
  v_mov_b32_dpp v233, v81 row_ror:8 row_mask:0xf bank_mask:0xf
  v_perm_b32 v132, v233, v81, v6
  v_mov_b32_dpp v234, v82 row_ror:8 row_mask:0xf bank_mask:0xf
  v_perm_b32 v136, v234, v82, v6
  s_waitcnt lgkmcnt(7)
  v_mfma_f32_32x32x16_bf16 a[32:47], v[52:55], a[108:111], a[32:47]
  global_load_dwordx4 v[212:215], v7, s[16:17] offset:16
  v_mov_b32_dpp v235, v83 row_ror:8 row_mask:0xf bank_mask:0xf
  v_permlane16_swap_b32 v128, v132
  v_perm_b32 v140, v235, v83, v6
  v_mov_b32_dpp v232, v84 row_ror:8 row_mask:0xf bank_mask:0xf
  v_perm_b32 v129, v232, v84, v6
  v_mfma_f32_32x32x16_bf16 a[48:63], v[60:63], a[108:111], a[48:63]
  ds_read_b128 a[108:111], v25 offset:65520
  v_permlane16_swap_b32 v136, v140
  v_mov_b32_dpp v233, v85 row_ror:8 row_mask:0xf bank_mask:0xf
  v_perm_b32 v133, v233, v85, v6
  v_mov_b32_dpp v234, v86 row_ror:8 row_mask:0xf bank_mask:0xf
  v_perm_b32 v137, v234, v86, v6
  s_waitcnt lgkmcnt(7)
  v_mfma_f32_32x32x16_bf16 a[64:79], v[48:51], a[112:115], 0
  buffer_load_dwordx4 v[120:123], v5, s[36:39], s6 offen
  global_load_dwordx4 v[216:219], v7, s[16:17] offset:32
  v_mov_b32_dpp v235, v87 row_ror:8 row_mask:0xf bank_mask:0xf
  v_permlane16_swap_b32 v129, v133
  v_perm_b32 v141, v235, v87, v6
  s_waitcnt vmcnt(11)
  v_mov_b32_dpp v232, v88 row_ror:8 row_mask:0xf bank_mask:0xf
  v_perm_b32 v130, v232, v88, v6
  v_mfma_f32_32x32x16_bf16 a[80:95], v[56:59], a[112:115], 0
  ds_read_b128 a[112:115], v33 offset:65504
  v_permlane16_swap_b32 v137, v141
  v_mov_b32_dpp v233, v89 row_ror:8 row_mask:0xf bank_mask:0xf
  v_perm_b32 v134, v233, v89, v6
  v_mov_b32_dpp v234, v90 row_ror:8 row_mask:0xf bank_mask:0xf
  v_perm_b32 v138, v234, v90, v6
  s_waitcnt lgkmcnt(7)
  v_mfma_f32_32x32x16_bf16 a[64:79], v[52:55], a[116:119], a[64:79]
  global_load_dwordx4 v[220:223], v7, s[16:17] offset:48
  v_mov_b32_dpp v235, v91 row_ror:8 row_mask:0xf bank_mask:0xf
  v_permlane16_swap_b32 v130, v134
  v_perm_b32 v142, v235, v91, v6
  v_mov_b32_dpp v232, v92 row_ror:8 row_mask:0xf bank_mask:0xf
  v_perm_b32 v131, v232, v92, v6
  v_mfma_f32_32x32x16_bf16 a[80:95], v[60:63], a[116:119], a[80:95]
  ds_read_b128 a[116:119], v33 offset:65520
  v_permlane16_swap_b32 v138, v142
  v_mov_b32_dpp v233, v93 row_ror:8 row_mask:0xf bank_mask:0xf
  v_perm_b32 v135, v233, v93, v6
  v_mov_b32_dpp v234, v94 row_ror:8 row_mask:0xf bank_mask:0xf
  v_perm_b32 v139, v234, v94, v6
  s_waitcnt lgkmcnt(7)
  v_mfma_f32_32x32x16_bf16 v[176:191], v[48:51], a[120:123], 0
  buffer_load_dwordx4 v[124:127], v5, s[36:39], s6 offen offset:2048
  v_mov_b32_dpp v235, v95 row_ror:8 row_mask:0xf bank_mask:0xf
  v_permlane16_swap_b32 v131, v135
  v_perm_b32 v143, v235, v95, v6
  v_mfma_f32_32x32x16_bf16 v[192:207], v[56:59], a[120:123], 0
  ds_read_b128 a[120:123], v41 offset:65504
  s_nop 1
  v_permlane16_swap_b32 v139, v143
  s_waitcnt lgkmcnt(7)
  v_mfma_f32_32x32x16_bf16 v[176:191], v[52:55], a[124:127], v[176:191]
  s_cmp_eq_u32 s46, 0
  s_cbranch_scc1 L_NOC
  s_lshl_b32 s43, s5, 2
  v_mov_b32 v243, s43
  v_mov_b32 v241, 1
  s_mov_b64 exec, 1
  global_atomic_add v241, v243, v241, s[24:25] sc0 sc1
  s_mov_b64 exec, -1
L_NOC:
  v_mfma_f32_32x32x16_bf16 v[192:207], v[60:63], a[124:127], v[192:207]
  ds_read_b128 a[124:127], v41 offset:65520
  s_waitcnt lgkmcnt(4)
  v_mfma_f32_32x32x16_bf16 a[0:15], v[128:131], a[96:99], a[0:15]
  s_mov_b32 s6, 524288
  buffer_load_dwordx4 v[160:163], v4, s[36:39], s6 offen
  s_waitcnt vmcnt(12)
  v_mov_b32_dpp v232, v96 row_ror:8 row_mask:0xf bank_mask:0xf
  v_perm_b32 v144, v232, v96, v6
  v_mov_b32_dpp v233, v97 row_ror:8 row_mask:0xf bank_mask:0xf
  v_perm_b32 v148, v233, v97, v6
  v_mfma_f32_32x32x16_bf16 a[16:31], v[136:139], a[96:99], a[16:31]
  ds_read_b128 a[96:99], v18 offset:65504
  v_mov_b32_dpp v234, v98 row_ror:8 row_mask:0xf bank_mask:0xf
  v_perm_b32 v152, v234, v98, v6
  v_mov_b32_dpp v235, v99 row_ror:8 row_mask:0xf bank_mask:0xf
  v_permlane16_swap_b32 v144, v148
  v_mfma_f32_32x32x16_bf16 a[0:15], v[132:135], a[100:103], a[0:15]
  v_perm_b32 v156, v235, v99, v6
  v_mov_b32_dpp v232, v100 row_ror:8 row_mask:0xf bank_mask:0xf
  v_perm_b32 v145, v232, v100, v6
  v_permlane16_swap_b32 v152, v156
  v_mov_b32_dpp v233, v101 row_ror:8 row_mask:0xf bank_mask:0xf
  v_mfma_f32_32x32x16_bf16 a[16:31], v[140:143], a[100:103], a[16:31]
  ds_read_b128 a[100:103], v18 offset:65520
  s_add_u32 s47, s41, 128
  buffer_load_dwordx4 a[192:195], v8, s[32:35], s47 offen
  buffer_load_dwordx4 a[128:131], v8, s[32:35], s47 offen offset:64
  s_add_u32 s52, s52, 0x8000
  buffer_load_dword v240, v251, s[36:39], s52 offen
  v_mfma_f32_32x32x16_bf16 a[32:47], v[128:131], a[104:107], a[32:47]
  buffer_load_dwordx4 v[164:167], v4, s[36:39], s6 offen offset:2048
  v_perm_b32 v149, v233, v101, v6
  v_mov_b32_dpp v234, v102 row_ror:8 row_mask:0xf bank_mask:0xf
  v_perm_b32 v153, v234, v102, v6
  v_mov_b32_dpp v235, v103 row_ror:8 row_mask:0xf bank_mask:0xf
  v_mfma_f32_32x32x16_bf16 a[48:63], v[136:139], a[104:107], a[48:63]
  ds_read_b128 a[104:107], v26 offset:65504
  v_permlane16_swap_b32 v145, v149
  v_perm_b32 v157, v235, v103, v6
  s_waitcnt vmcnt(14)
  v_mov_b32_dpp v232, v104 row_ror:8 row_mask:0xf bank_mask:0xf
  v_perm_b32 v146, v232, v104, v6
  v_mfma_f32_32x32x16_bf16 a[32:47], v[132:135], a[108:111], a[32:47]
  v_permlane16_swap_b32 v153, v157
  v_mov_b32_dpp v233, v105 row_ror:8 row_mask:0xf bank_mask:0xf
  v_perm_b32 v150, v233, v105, v6
  v_mov_b32_dpp v234, v106 row_ror:8 row_mask:0xf bank_mask:0xf
  v_perm_b32 v154, v234, v106, v6
  v_mfma_f32_32x32x16_bf16 a[48:63], v[140:143], a[108:111], a[48:63]
  ds_read_b128 a[108:111], v26 offset:65520
  v_mov_b32_dpp v235, v107 row_ror:8 row_mask:0xf bank_mask:0xf
  v_permlane16_swap_b32 v146, v150
  v_perm_b32 v158, v235, v107, v6
  s_waitcnt lgkmcnt(4)
  v_mfma_f32_32x32x16_bf16 a[64:79], v[128:131], a[112:115], a[64:79]
  buffer_load_dwordx4 v[168:171], v5, s[36:39], s6 offen
  v_mov_b32_dpp v232, v108 row_ror:8 row_mask:0xf bank_mask:0xf
  v_perm_b32 v147, v232, v108, v6
  v_permlane16_swap_b32 v154, v158
  v_mov_b32_dpp v233, v109 row_ror:8 row_mask:0xf bank_mask:0xf
  v_mfma_f32_32x32x16_bf16 a[80:95], v[136:139], a[112:115], a[80:95]
  ds_read_b128 a[112:115], v34 offset:65504
  v_perm_b32 v151, v233, v109, v6
  v_mov_b32_dpp v234, v110 row_ror:8 row_mask:0xf bank_mask:0xf
  v_perm_b32 v155, v234, v110, v6
  v_mov_b32_dpp v235, v111 row_ror:8 row_mask:0xf bank_mask:0xf
  v_mfma_f32_32x32x16_bf16 a[64:79], v[132:135], a[116:119], a[64:79]
  v_permlane16_swap_b32 v147, v151
  v_perm_b32 v159, v235, v111, v6
  v_mfma_f32_32x32x16_bf16 a[80:95], v[140:143], a[116:119], a[80:95]
  ds_read_b128 a[116:119], v34 offset:65520
  s_add_u32 s47, s41, 128
  buffer_load_dwordx4 a[196:199], v9, s[32:35], s47 offen offset:1040
  buffer_load_dwordx4 a[132:135], v9, s[32:35], s47 offen offset:1104
  v_mfma_f32_32x32x16_bf16 v[176:191], v[128:131], a[120:123], v[176:191]
  buffer_load_dwordx4 v[172:175], v5, s[36:39], s6 offen offset:2048
  s_nop 1
  v_permlane16_swap_b32 v155, v159
  v_mfma_f32_32x32x16_bf16 v[192:207], v[136:139], a[120:123], v[192:207]
  ds_read_b128 a[120:123], v42 offset:65504
  v_mfma_f32_32x32x16_bf16 v[176:191], v[132:135], a[124:127], v[176:191]
  v_mfma_f32_32x32x16_bf16 v[192:207], v[140:143], a[124:127], v[192:207]
  ds_read_b128 a[124:127], v42 offset:65520
  s_waitcnt lgkmcnt(4)
  v_mfma_f32_32x32x16_bf16 a[0:15], v[144:147], a[96:99], a[0:15]
  s_mov_b32 s6, 655360
  buffer_load_dwordx4 v[80:83], v4, s[36:39], s6 offen
  s_waitcnt vmcnt(16)
  v_mov_b32_dpp v232, v112 row_ror:8 row_mask:0xf bank_mask:0xf
  v_perm_b32 v64, v232, v112, v6
  v_mov_b32_dpp v233, v113 row_ror:8 row_mask:0xf bank_mask:0xf
  v_mfma_f32_32x32x16_bf16 a[16:31], v[152:155], a[96:99], a[16:31]
  ds_read_b128 a[96:99], v19 offset:65504
  v_perm_b32 v68, v233, v113, v6
  v_mov_b32_dpp v234, v114 row_ror:8 row_mask:0xf bank_mask:0xf
  v_perm_b32 v72, v234, v114, v6
  v_mov_b32_dpp v235, v115 row_ror:8 row_mask:0xf bank_mask:0xf
  v_mfma_f32_32x32x16_bf16 a[0:15], v[148:151], a[100:103], a[0:15]
  v_permlane16_swap_b32 v64, v68
  v_perm_b32 v76, v235, v115, v6
  v_mov_b32_dpp v232, v116 row_ror:8 row_mask:0xf bank_mask:0xf
  v_perm_b32 v65, v232, v116, v6
  v_mfma_f32_32x32x16_bf16 a[16:31], v[156:159], a[100:103], a[16:31]
  ds_read_b128 a[100:103], v19 offset:65520
  v_permlane16_swap_b32 v72, v76
  v_mov_b32_dpp v233, v117 row_ror:8 row_mask:0xf bank_mask:0xf
  v_perm_b32 v69, v233, v117, v6
  v_mfma_f32_32x32x16_bf16 a[32:47], v[144:147], a[104:107], a[32:47]
  buffer_load_dwordx4 v[84:87], v4, s[36:39], s6 offen offset:2048
  v_mov_b32_dpp v234, v118 row_ror:8 row_mask:0xf bank_mask:0xf
  v_perm_b32 v73, v234, v118, v6
  v_mov_b32_dpp v235, v119 row_ror:8 row_mask:0xf bank_mask:0xf
  v_mfma_f32_32x32x16_bf16 a[48:63], v[152:155], a[104:107], a[48:63]
  ds_read_b128 a[104:107], v27 offset:65504
  v_permlane16_swap_b32 v65, v69
  v_perm_b32 v77, v235, v119, v6
  s_waitcnt vmcnt(11)
  v_mov_b32_dpp v232, v120 row_ror:8 row_mask:0xf bank_mask:0xf
  v_mfma_f32_32x32x16_bf16 a[32:47], v[148:151], a[108:111], a[32:47]
  v_perm_b32 v66, v232, v120, v6
  v_permlane16_swap_b32 v73, v77
  v_mov_b32_dpp v233, v121 row_ror:8 row_mask:0xf bank_mask:0xf
  v_perm_b32 v70, v233, v121, v6
  v_mfma_f32_32x32x16_bf16 a[48:63], v[156:159], a[108:111], a[48:63]
  ds_read_b128 a[108:111], v27 offset:65520
  v_mov_b32_dpp v234, v122 row_ror:8 row_mask:0xf bank_mask:0xf
  v_perm_b32 v74, v234, v122, v6
  v_mov_b32_dpp v235, v123 row_ror:8 row_mask:0xf bank_mask:0xf
  s_waitcnt lgkmcnt(4)
  v_mfma_f32_32x32x16_bf16 a[64:79], v[144:147], a[112:115], a[64:79]
  buffer_load_dwordx4 v[88:91], v5, s[36:39], s6 offen
  v_permlane16_swap_b32 v66, v70
  v_perm_b32 v78, v235, v123, v6
  v_mov_b32_dpp v232, v124 row_ror:8 row_mask:0xf bank_mask:0xf
  v_mfma_f32_32x32x16_bf16 a[80:95], v[152:155], a[112:115], a[80:95]
  ds_read_b128 a[112:115], v35 offset:65504
  v_perm_b32 v67, v232, v124, v6
  v_permlane16_swap_b32 v74, v78
  v_mov_b32_dpp v233, v125 row_ror:8 row_mask:0xf bank_mask:0xf
  v_mfma_f32_32x32x16_bf16 a[64:79], v[148:151], a[116:119], a[64:79]
  s_add_u32 s47, s41, 128
  buffer_load_dwordx4 a[200:203], v10, s[32:35], s47 offen offset:2080
  buffer_load_dwordx4 a[136:139], v10, s[32:35], s47 offen offset:2144
  v_perm_b32 v71, v233, v125, v6
  v_mov_b32_dpp v234, v126 row_ror:8 row_mask:0xf bank_mask:0xf
  v_mfma_f32_32x32x16_bf16 a[80:95], v[156:159], a[116:119], a[80:95]
  ds_read_b128 a[116:119], v35 offset:65520
  v_perm_b32 v75, v234, v126, v6
  v_mov_b32_dpp v235, v127 row_ror:8 row_mask:0xf bank_mask:0xf
  v_permlane16_swap_b32 v67, v71
  v_mfma_f32_32x32x16_bf16 v[176:191], v[144:147], a[120:123], v[176:191]
  buffer_load_dwordx4 v[92:95], v5, s[36:39], s6 offen offset:2048
  v_perm_b32 v79, v235, v127, v6
  v_mfma_f32_32x32x16_bf16 v[192:207], v[152:155], a[120:123], v[192:207]
  ds_read_b128 a[120:123], v43 offset:65504
  s_nop 1
  v_permlane16_swap_b32 v75, v79
  v_mfma_f32_32x32x16_bf16 v[176:191], v[148:151], a[124:127], v[176:191]
  v_mfma_f32_32x32x16_bf16 v[192:207], v[156:159], a[124:127], v[192:207]
  ds_read_b128 a[124:127], v43 offset:65520
  s_waitcnt lgkmcnt(4)
  v_mfma_f32_32x32x16_bf16 a[0:15], v[64:67], a[96:99], a[0:15]
  s_add_u32 s6, s7, 0
  buffer_load_dwordx4 v[96:99], v4, s[36:39], s6 offen
  s_waitcnt vmcnt(11)
  v_mov_b32_dpp v232, v160 row_ror:8 row_mask:0xf bank_mask:0xf
  v_perm_b32 v48, v232, v160, v6
  v_mov_b32_dpp v233, v161 row_ror:8 row_mask:0xf bank_mask:0xf
  v_perm_b32 v52, v233, v161, v6
  v_mfma_f32_32x32x16_bf16 a[16:31], v[72:75], a[96:99], a[16:31]
  ds_read_b128 a[96:99], v20 offset:65504
  v_mov_b32_dpp v234, v162 row_ror:8 row_mask:0xf bank_mask:0xf
  v_perm_b32 v56, v234, v162, v6
  v_mov_b32_dpp v235, v163 row_ror:8 row_mask:0xf bank_mask:0xf
  v_permlane16_swap_b32 v48, v52
  v_lshlrev_b32 v242, 16, v208
  v_and_b32 v208, 0xffff0000, v208
  v_mfma_f32_32x32x16_bf16 a[0:15], v[68:71], a[100:103], a[0:15]
  v_perm_b32 v60, v235, v163, v6
  v_mov_b32_dpp v232, v164 row_ror:8 row_mask:0xf bank_mask:0xf
  v_perm_b32 v49, v232, v164, v6
  v_permlane16_swap_b32 v56, v60
  v_mov_b32_dpp v233, v165 row_ror:8 row_mask:0xf bank_mask:0xf
  v_add_f32 v176, v176, v242
  v_add_f32 v180, v180, v208
  v_mfma_f32_32x32x16_bf16 a[16:31], v[76:79], a[100:103], a[16:31]
  ds_read_b128 a[100:103], v20 offset:65520
  s_add_u32 s47, s41, 128
  buffer_load_dwordx4 a[204:207], v11, s[32:35], s47 offen offset:3120
  buffer_load_dwordx4 a[140:143], v11, s[32:35], s47 offen offset:3184
  v_perm_b32 v53, v233, v165, v6
  v_mov_b32_dpp v234, v166 row_ror:8 row_mask:0xf bank_mask:0xf
  v_lshlrev_b32 v242, 16, v212
  v_and_b32 v212, 0xffff0000, v212
  v_mfma_f32_32x32x16_bf16 a[32:47], v[64:67], a[104:107], a[32:47]
  buffer_load_dwordx4 v[100:103], v4, s[36:39], s6 offen offset:2048
  v_perm_b32 v57, v234, v166, v6
  v_mov_b32_dpp v235, v167 row_ror:8 row_mask:0xf bank_mask:0xf
  v_permlane16_swap_b32 v49, v53
  v_perm_b32 v61, v235, v167, v6
  v_add_f32 v177, v177, v242
  v_add_f32 v181, v181, v212
  v_mfma_f32_32x32x16_bf16 a[48:63], v[72:75], a[104:107], a[48:63]
  ds_read_b128 a[104:107], v28 offset:65504
  s_waitcnt vmcnt(10)
  v_mov_b32_dpp v232, v168 row_ror:8 row_mask:0xf bank_mask:0xf
  v_perm_b32 v50, v232, v168, v6
  v_permlane16_swap_b32 v57, v61
  v_mov_b32_dpp v233, v169 row_ror:8 row_mask:0xf bank_mask:0xf
  v_lshlrev_b32 v242, 16, v216
  v_and_b32 v216, 0xffff0000, v216
  v_mfma_f32_32x32x16_bf16 a[32:47], v[68:71], a[108:111], a[32:47]
  v_perm_b32 v54, v233, v169, v6
  v_mov_b32_dpp v234, v170 row_ror:8 row_mask:0xf bank_mask:0xf
  v_perm_b32 v58, v234, v170, v6
  v_mov_b32_dpp v235, v171 row_ror:8 row_mask:0xf bank_mask:0xf
  v_permlane16_swap_b32 v50, v54
  v_add_f32 v178, v178, v242
  v_add_f32 v182, v182, v216
  v_mfma_f32_32x32x16_bf16 a[48:63], v[76:79], a[108:111], a[48:63]
  ds_read_b128 a[108:111], v28 offset:65520
  v_perm_b32 v62, v235, v171, v6
  v_mov_b32_dpp v232, v172 row_ror:8 row_mask:0xf bank_mask:0xf
  v_perm_b32 v51, v232, v172, v6
  v_lshlrev_b32 v242, 16, v220
  v_and_b32 v220, 0xffff0000, v220
  v_add_f32 v179, v179, v242
  s_waitcnt lgkmcnt(4)
  v_mfma_f32_32x32x16_bf16 a[64:79], v[64:67], a[112:115], a[64:79]
  buffer_load_dwordx4 v[104:107], v5, s[36:39], s6 offen
  v_permlane16_swap_b32 v58, v62
  v_mov_b32_dpp v233, v173 row_ror:8 row_mask:0xf bank_mask:0xf
  v_perm_b32 v55, v233, v173, v6
  v_mov_b32_dpp v234, v174 row_ror:8 row_mask:0xf bank_mask:0xf
  v_add_f32 v183, v183, v220
  v_mfma_f32_32x32x16_bf16 a[80:95], v[72:75], a[112:115], a[80:95]
  ds_read_b128 a[112:115], v36 offset:65504
  v_perm_b32 v59, v234, v174, v6
  v_mov_b32_dpp v235, v175 row_ror:8 row_mask:0xf bank_mask:0xf
  v_permlane16_swap_b32 v51, v55
  v_perm_b32 v63, v235, v175, v6
  v_mfma_f32_32x32x16_bf16 a[64:79], v[68:71], a[116:119], a[64:79]
  s_nop 1
  v_permlane16_swap_b32 v59, v63
  v_mfma_f32_32x32x16_bf16 a[80:95], v[76:79], a[116:119], a[80:95]
  ds_read_b128 a[116:119], v36 offset:65520
  s_add_u32 s47, s41, 16512
  buffer_load_dwordx4 a[208:211], v8, s[32:35], s47 offen
  buffer_load_dwordx4 a[144:147], v8, s[32:35], s47 offen offset:64
  v_mfma_f32_32x32x16_bf16 v[176:191], v[64:67], a[120:123], v[176:191]
  buffer_load_dwordx4 v[108:111], v5, s[36:39], s6 offen offset:2048
  v_mfma_f32_32x32x16_bf16 v[192:207], v[72:75], a[120:123], v[192:207]
  ds_read_b128 a[120:123], v44 offset:65504
  v_mfma_f32_32x32x16_bf16 v[176:191], v[68:71], a[124:127], v[176:191]
  v_mfma_f32_32x32x16_bf16 v[192:207], v[76:79], a[124:127], v[192:207]
  ds_read_b128 a[124:127], v44 offset:65520
  s_waitcnt lgkmcnt(4)
  v_mfma_f32_32x32x16_bf16 a[0:15], v[48:51], a[96:99], a[0:15]
  s_mov_b32 s6, 32768
  buffer_load_dwordx4 v[112:115], v4, s[36:39], s6 offen
  s_waitcnt vmcnt(13)
  v_mov_b32_dpp v232, v80 row_ror:8 row_mask:0xf bank_mask:0xf
  v_perm_b32 v128, v232, v80, v6
  v_mov_b32_dpp v233, v81 row_ror:8 row_mask:0xf bank_mask:0xf
  v_mfma_f32_32x32x16_bf16 a[16:31], v[56:59], a[96:99], a[16:31]
  ds_read_b128 a[96:99], v21 offset:65504
  v_perm_b32 v132, v233, v81, v6
  v_mov_b32_dpp v234, v82 row_ror:8 row_mask:0xf bank_mask:0xf
  v_perm_b32 v136, v234, v82, v6
  v_mov_b32_dpp v235, v83 row_ror:8 row_mask:0xf bank_mask:0xf
  v_lshlrev_b32 v242, 16, v209
  v_and_b32 v209, 0xffff0000, v209
  v_mfma_f32_32x32x16_bf16 a[0:15], v[52:55], a[100:103], a[0:15]
  v_permlane16_swap_b32 v128, v132
  v_perm_b32 v140, v235, v83, v6
  v_mov_b32_dpp v232, v84 row_ror:8 row_mask:0xf bank_mask:0xf
  v_perm_b32 v129, v232, v84, v6
  v_add_f32 v184, v184, v242
  v_add_f32 v188, v188, v209
  v_mfma_f32_32x32x16_bf16 a[16:31], v[60:63], a[100:103], a[16:31]
  ds_read_b128 a[100:103], v21 offset:65520
  v_permlane16_swap_b32 v136, v140
  v_mov_b32_dpp v233, v85 row_ror:8 row_mask:0xf bank_mask:0xf
  v_perm_b32 v133, v233, v85, v6
  v_lshlrev_b32 v242, 16, v213
  v_and_b32 v213, 0xffff0000, v213
  v_mfma_f32_32x32x16_bf16 a[32:47], v[48:51], a[104:107], a[32:47]
  buffer_load_dwordx4 v[116:119], v4, s[36:39], s6 offen offset:2048
  v_mov_b32_dpp v234, v86 row_ror:8 row_mask:0xf bank_mask:0xf
  v_perm_b32 v137, v234, v86, v6
  v_mov_b32_dpp v235, v87 row_ror:8 row_mask:0xf bank_mask:0xf
  v_add_f32 v185, v185, v242
  v_add_f32 v189, v189, v213
  v_lshlrev_b32 v242, 16, v217
  v_mfma_f32_32x32x16_bf16 a[48:63], v[56:59], a[104:107], a[48:63]
  ds_read_b128 a[104:107], v29 offset:65504
  v_permlane16_swap_b32 v129, v133
  v_perm_b32 v141, v235, v87, v6
  s_waitcnt vmcnt(10)
  v_mov_b32_dpp v232, v88 row_ror:8 row_mask:0xf bank_mask:0xf
  v_and_b32 v217, 0xffff0000, v217
  v_add_f32 v186, v186, v242
  v_mfma_f32_32x32x16_bf16 a[32:47], v[52:55], a[108:111], a[32:47]
  v_perm_b32 v130, v232, v88, v6
  v_permlane16_swap_b32 v137, v141
  v_mov_b32_dpp v233, v89 row_ror:8 row_mask:0xf bank_mask:0xf
  v_perm_b32 v134, v233, v89, v6
  v_add_f32 v190, v190, v217
  v_lshlrev_b32 v242, 16, v221
  v_mfma_f32_32x32x16_bf16 a[48:63], v[60:63], a[108:111], a[48:63]
  ds_read_b128 a[108:111], v29 offset:65520
  v_mov_b32_dpp v234, v90 row_ror:8 row_mask:0xf bank_mask:0xf
  v_perm_b32 v138, v234, v90, v6
  v_mov_b32_dpp v235, v91 row_ror:8 row_mask:0xf bank_mask:0xf
  v_and_b32 v221, 0xffff0000, v221
  v_add_f32 v187, v187, v242
  s_waitcnt lgkmcnt(4)
  v_mfma_f32_32x32x16_bf16 a[64:79], v[48:51], a[112:115], a[64:79]
  buffer_load_dwordx4 v[120:123], v5, s[36:39], s6 offen
  v_permlane16_swap_b32 v130, v134
  v_perm_b32 v142, v235, v91, v6
  v_mov_b32_dpp v232, v92 row_ror:8 row_mask:0xf bank_mask:0xf
  v_add_f32 v191, v191, v221
  v_mfma_f32_32x32x16_bf16 a[80:95], v[56:59], a[112:115], a[80:95]
  ds_read_b128 a[112:115], v37 offset:65504
  v_perm_b32 v131, v232, v92, v6
  v_permlane16_swap_b32 v138, v142
  v_mov_b32_dpp v233, v93 row_ror:8 row_mask:0xf bank_mask:0xf
  v_mfma_f32_32x32x16_bf16 a[64:79], v[52:55], a[116:119], a[64:79]
  s_add_u32 s47, s41, 16512
  buffer_load_dwordx4 a[212:215], v9, s[32:35], s47 offen offset:1040
  buffer_load_dwordx4 a[148:151], v9, s[32:35], s47 offen offset:1104
  v_perm_b32 v135, v233, v93, v6
  v_mov_b32_dpp v234, v94 row_ror:8 row_mask:0xf bank_mask:0xf
  v_mfma_f32_32x32x16_bf16 a[80:95], v[60:63], a[116:119], a[80:95]
  ds_read_b128 a[116:119], v37 offset:65520
  v_perm_b32 v139, v234, v94, v6
  v_mov_b32_dpp v235, v95 row_ror:8 row_mask:0xf bank_mask:0xf
  v_permlane16_swap_b32 v131, v135
  v_mfma_f32_32x32x16_bf16 v[176:191], v[48:51], a[120:123], v[176:191]
  buffer_load_dwordx4 v[124:127], v5, s[36:39], s6 offen offset:2048
  v_perm_b32 v143, v235, v95, v6
  v_mfma_f32_32x32x16_bf16 v[192:207], v[56:59], a[120:123], v[192:207]
  ds_read_b128 a[120:123], v45 offset:65504
  s_nop 1
  v_permlane16_swap_b32 v139, v143
  v_mfma_f32_32x32x16_bf16 v[176:191], v[52:55], a[124:127], v[176:191]
  s_cmp_eq_u32 s46, 0
  s_cbranch_scc1 L_NOW
  s_waitcnt vmcnt(29)
  v_readfirstlane_b32 s43, v241
  s_cmp_lg_u32 s43, 0
  s_cselect_b32 s46, 0, 1
  s_cbranch_scc1 L_NOW
  s_lshl_b32 s43, s5, 10
  v_lshlrev_b32 v243, 3, v1
  v_add_u32 v243, s43, v243
  global_atomic_swap_x2 v[224:225], v243, v[246:247], s[26:27] sc0 sc1
  global_atomic_swap_x2 v[226:227], v243, v[246:247], s[26:27] offset:512 sc0 sc1
L_NOW:
  v_mfma_f32_32x32x16_bf16 v[192:207], v[60:63], a[124:127], v[192:207]
  ds_read_b128 a[124:127], v45 offset:65520
  s_waitcnt lgkmcnt(4)
  v_mfma_f32_32x32x16_bf16 a[0:15], v[128:131], a[96:99], a[0:15]
  s_mov_b32 s6, 163840
  buffer_load_dwordx4 v[160:163], v4, s[36:39], s6 offen
  s_waitcnt vmcnt(11)
  v_mov_b32_dpp v232, v96 row_ror:8 row_mask:0xf bank_mask:0xf
  v_perm_b32 v144, v232, v96, v6
  v_mov_b32_dpp v233, v97 row_ror:8 row_mask:0xf bank_mask:0xf
  v_perm_b32 v148, v233, v97, v6
  v_mfma_f32_32x32x16_bf16 a[16:31], v[136:139], a[96:99], a[16:31]
  ds_read_b128 a[96:99], v22
  v_mov_b32_dpp v234, v98 row_ror:8 row_mask:0xf bank_mask:0xf
  v_perm_b32 v152, v234, v98, v6
  v_mov_b32_dpp v235, v99 row_ror:8 row_mask:0xf bank_mask:0xf
  v_permlane16_swap_b32 v144, v148
  v_lshlrev_b32 v242, 16, v210
  v_and_b32 v210, 0xffff0000, v210
  v_mfma_f32_32x32x16_bf16 a[0:15], v[132:135], a[100:103], a[0:15]
  v_perm_b32 v156, v235, v99, v6
  v_mov_b32_dpp v232, v100 row_ror:8 row_mask:0xf bank_mask:0xf
  v_perm_b32 v145, v232, v100, v6
  v_permlane16_swap_b32 v152, v156
  v_mov_b32_dpp v233, v101 row_ror:8 row_mask:0xf bank_mask:0xf
  v_add_f32 v192, v192, v242
  v_add_f32 v196, v196, v210
  v_mfma_f32_32x32x16_bf16 a[16:31], v[140:143], a[100:103], a[16:31]
  ds_read_b128 a[100:103], v22 offset:16
  s_add_u32 s47, s41, 16512
  buffer_load_dwordx4 a[216:219], v10, s[32:35], s47 offen offset:2080
  buffer_load_dwordx4 a[152:155], v10, s[32:35], s47 offen offset:2144
  s_add_u32 s52, s52, 0x8000
  buffer_load_dword v240, v251, s[36:39], s52 offen
  v_lshlrev_b32 v242, 16, v214
  v_and_b32 v214, 0xffff0000, v214
  v_mfma_f32_32x32x16_bf16 a[32:47], v[128:131], a[104:107], a[32:47]
  buffer_load_dwordx4 v[164:167], v4, s[36:39], s6 offen offset:2048
  v_perm_b32 v149, v233, v101, v6
  v_mov_b32_dpp v234, v102 row_ror:8 row_mask:0xf bank_mask:0xf
  v_perm_b32 v153, v234, v102, v6
  v_mov_b32_dpp v235, v103 row_ror:8 row_mask:0xf bank_mask:0xf
  v_add_f32 v193, v193, v242
  v_add_f32 v197, v197, v214
  v_lshlrev_b32 v242, 16, v218
  v_mfma_f32_32x32x16_bf16 a[48:63], v[136:139], a[104:107], a[48:63]
  ds_read_b128 a[104:107], v30
  v_permlane16_swap_b32 v145, v149
  v_perm_b32 v157, v235, v103, v6
  s_waitcnt vmcnt(11)
  v_mov_b32_dpp v232, v104 row_ror:8 row_mask:0xf bank_mask:0xf
  v_perm_b32 v146, v232, v104, v6
  v_and_b32 v218, 0xffff0000, v218
  v_add_f32 v194, v194, v242
  v_mfma_f32_32x32x16_bf16 a[32:47], v[132:135], a[108:111], a[32:47]
  v_permlane16_swap_b32 v153, v157
  v_mov_b32_dpp v233, v105 row_ror:8 row_mask:0xf bank_mask:0xf
  v_perm_b32 v150, v233, v105, v6
  v_mov_b32_dpp v234, v106 row_ror:8 row_mask:0xf bank_mask:0xf
  v_perm_b32 v154, v234, v106, v6
  v_add_f32 v198, v198, v218
  v_lshlrev_b32 v242, 16, v222
  v_mfma_f32_32x32x16_bf16 a[48:63], v[140:143], a[108:111], a[48:63]
  ds_read_b128 a[108:111], v30 offset:16
  v_mov_b32_dpp v235, v107 row_ror:8 row_mask:0xf bank_mask:0xf
  v_permlane16_swap_b32 v146, v150
  v_perm_b32 v158, v235, v107, v6
  v_and_b32 v222, 0xffff0000, v222
  v_add_f32 v195, v195, v242
  s_waitcnt lgkmcnt(4)
  v_mfma_f32_32x32x16_bf16 a[64:79], v[128:131], a[112:115], a[64:79]
  buffer_load_dwordx4 v[168:171], v5, s[36:39], s6 offen
  v_mov_b32_dpp v232, v108 row_ror:8 row_mask:0xf bank_mask:0xf
  v_perm_b32 v147, v232, v108, v6
  v_permlane16_swap_b32 v154, v158
  v_mov_b32_dpp v233, v109 row_ror:8 row_mask:0xf bank_mask:0xf
  v_add_f32 v199, v199, v222
  v_mfma_f32_32x32x16_bf16 a[80:95], v[136:139], a[112:115], a[80:95]
  ds_read_b128 a[112:115], v38
  v_perm_b32 v151, v233, v109, v6
  v_mov_b32_dpp v234, v110 row_ror:8 row_mask:0xf bank_mask:0xf
  v_perm_b32 v155, v234, v110, v6
  v_mov_b32_dpp v235, v111 row_ror:8 row_mask:0xf bank_mask:0xf
  v_mfma_f32_32x32x16_bf16 a[64:79], v[132:135], a[116:119], a[64:79]
  v_permlane16_swap_b32 v147, v151
  v_perm_b32 v159, v235, v111, v6
  v_mfma_f32_32x32x16_bf16 a[80:95], v[140:143], a[116:119], a[80:95]
  ds_read_b128 a[116:119], v38 offset:16
  s_add_u32 s47, s41, 16512
  buffer_load_dwordx4 a[220:223], v11, s[32:35], s47 offen offset:3120
  buffer_load_dwordx4 a[156:159], v11, s[32:35], s47 offen offset:3184
  v_mfma_f32_32x32x16_bf16 v[176:191], v[128:131], a[120:123], v[176:191]
  buffer_load_dwordx4 v[172:175], v5, s[36:39], s6 offen offset:2048
  s_nop 1
  v_permlane16_swap_b32 v155, v159
  v_mfma_f32_32x32x16_bf16 v[192:207], v[136:139], a[120:123], v[192:207]
  ds_read_b128 a[120:123], v46
  v_mfma_f32_32x32x16_bf16 v[176:191], v[132:135], a[124:127], v[176:191]
  v_mfma_f32_32x32x16_bf16 v[192:207], v[140:143], a[124:127], v[192:207]
  ds_read_b128 a[124:127], v46 offset:16
  s_waitcnt lgkmcnt(4)
  v_mfma_f32_32x32x16_bf16 a[0:15], v[144:147], a[96:99], a[0:15]
  s_mov_b32 s6, 294912
  buffer_load_dwordx4 v[80:83], v4, s[36:39], s6 offen
  s_waitcnt vmcnt(14)
  v_mov_b32_dpp v232, v112 row_ror:8 row_mask:0xf bank_mask:0xf
  v_perm_b32 v64, v232, v112, v6
  v_mov_b32_dpp v233, v113 row_ror:8 row_mask:0xf bank_mask:0xf
  v_mfma_f32_32x32x16_bf16 a[16:31], v[152:155], a[96:99], a[16:31]
  ds_read_b128 a[96:99], v16
  v_perm_b32 v68, v233, v113, v6
  v_mov_b32_dpp v234, v114 row_ror:8 row_mask:0xf bank_mask:0xf
  v_perm_b32 v72, v234, v114, v6
  v_mov_b32_dpp v235, v115 row_ror:8 row_mask:0xf bank_mask:0xf
  v_lshlrev_b32 v242, 16, v211
  v_and_b32 v211, 0xffff0000, v211
  v_mfma_f32_32x32x16_bf16 a[0:15], v[148:151], a[100:103], a[0:15]
  v_permlane16_swap_b32 v64, v68
  v_perm_b32 v76, v235, v115, v6
  v_mov_b32_dpp v232, v116 row_ror:8 row_mask:0xf bank_mask:0xf
  v_perm_b32 v65, v232, v116, v6
  v_add_f32 v200, v200, v242
  v_add_f32 v204, v204, v211
  v_mfma_f32_32x32x16_bf16 a[16:31], v[156:159], a[100:103], a[16:31]
  ds_read_b128 a[100:103], v16 offset:16
  v_permlane16_swap_b32 v72, v76
  v_mov_b32_dpp v233, v117 row_ror:8 row_mask:0xf bank_mask:0xf
  v_perm_b32 v69, v233, v117, v6
  v_lshlrev_b32 v242, 16, v215
  v_and_b32 v215, 0xffff0000, v215
  v_mfma_f32_32x32x16_bf16 a[32:47], v[144:147], a[104:107], a[32:47]
  buffer_load_dwordx4 v[84:87], v4, s[36:39], s6 offen offset:2048
  v_mov_b32_dpp v234, v118 row_ror:8 row_mask:0xf bank_mask:0xf
  v_perm_b32 v73, v234, v118, v6
  v_mov_b32_dpp v235, v119 row_ror:8 row_mask:0xf bank_mask:0xf
  v_add_f32 v201, v201, v242
  v_add_f32 v205, v205, v215
  v_lshlrev_b32 v242, 16, v219
  v_mfma_f32_32x32x16_bf16 a[48:63], v[152:155], a[104:107], a[48:63]
  ds_read_b128 a[104:107], v24
  v_permlane16_swap_b32 v65, v69
  v_perm_b32 v77, v235, v119, v6
  s_waitcnt vmcnt(11)
  v_mov_b32_dpp v232, v120 row_ror:8 row_mask:0xf bank_mask:0xf
  v_and_b32 v219, 0xffff0000, v219
  v_add_f32 v202, v202, v242
  v_mfma_f32_32x32x16_bf16 a[32:47], v[148:151], a[108:111], a[32:47]
  v_perm_b32 v66, v232, v120, v6
  v_permlane16_swap_b32 v73, v77
  v_mov_b32_dpp v233, v121 row_ror:8 row_mask:0xf bank_mask:0xf
  v_perm_b32 v70, v233, v121, v6
  v_add_f32 v206, v206, v219
  v_lshlrev_b32 v242, 16, v223
  v_mfma_f32_32x32x16_bf16 a[48:63], v[156:159], a[108:111], a[48:63]
  ds_read_b128 a[108:111], v24 offset:16
  v_mov_b32_dpp v234, v122 row_ror:8 row_mask:0xf bank_mask:0xf
  v_perm_b32 v74, v234, v122, v6
  v_mov_b32_dpp v235, v123 row_ror:8 row_mask:0xf bank_mask:0xf
  v_and_b32 v223, 0xffff0000, v223
  v_add_f32 v203, v203, v242
  s_waitcnt lgkmcnt(4)
  v_mfma_f32_32x32x16_bf16 a[64:79], v[144:147], a[112:115], a[64:79]
  buffer_load_dwordx4 v[88:91], v5, s[36:39], s6 offen
  v_permlane16_swap_b32 v66, v70
  v_perm_b32 v78, v235, v123, v6
  v_mov_b32_dpp v232, v124 row_ror:8 row_mask:0xf bank_mask:0xf
  v_add_f32 v207, v207, v223
  v_mfma_f32_32x32x16_bf16 a[80:95], v[152:155], a[112:115], a[80:95]
  ds_read_b128 a[112:115], v32
  v_perm_b32 v67, v232, v124, v6
  v_permlane16_swap_b32 v74, v78
  v_mov_b32_dpp v233, v125 row_ror:8 row_mask:0xf bank_mask:0xf
  v_mfma_f32_32x32x16_bf16 a[64:79], v[148:151], a[116:119], a[64:79]
  s_add_u32 s47, s41, 32896
  buffer_load_dwordx4 a[224:227], v8, s[32:35], s47 offen
  buffer_load_dwordx4 a[160:163], v8, s[32:35], s47 offen offset:64
  v_perm_b32 v71, v233, v125, v6
  v_mov_b32_dpp v234, v126 row_ror:8 row_mask:0xf bank_mask:0xf
  v_mfma_f32_32x32x16_bf16 a[80:95], v[156:159], a[116:119], a[80:95]
  ds_read_b128 a[116:119], v32 offset:16
  v_perm_b32 v75, v234, v126, v6
  v_mov_b32_dpp v235, v127 row_ror:8 row_mask:0xf bank_mask:0xf
  v_permlane16_swap_b32 v67, v71
  v_mfma_f32_32x32x16_bf16 v[176:191], v[144:147], a[120:123], v[176:191]
  buffer_load_dwordx4 v[92:95], v5, s[36:39], s6 offen offset:2048
  v_perm_b32 v79, v235, v127, v6
  v_mfma_f32_32x32x16_bf16 v[192:207], v[152:155], a[120:123], v[192:207]
  ds_read_b128 a[120:123], v40
  s_nop 1
  v_permlane16_swap_b32 v75, v79
  v_mfma_f32_32x32x16_bf16 v[176:191], v[148:151], a[124:127], v[176:191]
  v_mfma_f32_32x32x16_bf16 v[192:207], v[156:159], a[124:127], v[192:207]
  ds_read_b128 a[124:127], v40 offset:16
  s_waitcnt lgkmcnt(4)
  s_barrier
  v_mfma_f32_32x32x16_bf16 a[0:15], v[64:67], a[96:99], a[0:15]
  s_mov_b32 s6, 425984
  buffer_load_dwordx4 v[96:99], v4, s[36:39], s6 offen
  s_waitcnt vmcnt(11)
  v_mov_b32_dpp v232, v160 row_ror:8 row_mask:0xf bank_mask:0xf
  v_perm_b32 v48, v232, v160, v6
  v_mov_b32_dpp v233, v161 row_ror:8 row_mask:0xf bank_mask:0xf
  v_perm_b32 v52, v233, v161, v6
  v_mov_b32_dpp v234, v162 row_ror:8 row_mask:0xf bank_mask:0xf
  v_mfma_f32_32x32x16_bf16 a[16:31], v[72:75], a[96:99], a[16:31]
  ds_read_b128 a[96:99], v17
  v_perm_b32 v56, v234, v162, v6
  v_mov_b32_dpp v235, v163 row_ror:8 row_mask:0xf bank_mask:0xf
  v_permlane16_swap_b32 v48, v52
  v_perm_b32 v60, v235, v163, v6
  v_mov_b32_dpp v232, v164 row_ror:8 row_mask:0xf bank_mask:0xf
  v_mfma_f32_32x32x16_bf16 a[0:15], v[68:71], a[100:103], a[0:15]
  v_perm_b32 v49, v232, v164, v6
  v_permlane16_swap_b32 v56, v60
  v_mov_b32_dpp v233, v165 row_ror:8 row_mask:0xf bank_mask:0xf
  v_perm_b32 v53, v233, v165, v6
  v_mov_b32_dpp v234, v166 row_ror:8 row_mask:0xf bank_mask:0xf
  v_perm_b32 v57, v234, v166, v6
  v_mfma_f32_32x32x16_bf16 a[16:31], v[76:79], a[100:103], a[16:31]
  ds_read_b128 a[100:103], v17 offset:16
  s_add_u32 s47, s41, 32896
  s_add_u32 m0, s40, 73824
  s_nop 0
  buffer_load_dwordx4 v9, s[32:35], s47 offen offset:1040 lds
  buffer_load_dwordx4 a[164:167], v9, s[32:35], s47 offen offset:1104
  v_mov_b32_dpp v235, v167 row_ror:8 row_mask:0xf bank_mask:0xf
  v_mfma_f32_32x32x16_bf16 a[32:47], v[64:67], a[104:107], a[32:47]
  buffer_load_dwordx4 v[100:103], v4, s[36:39], s6 offen offset:2048
  ds_write_b128 v248, a[192:195]
  v_mfma_f32_32x32x16_bf16 a[48:63], v[72:75], a[104:107], a[48:63]
  ds_read_b128 a[104:107], v25
  v_permlane16_swap_b32 v49, v53
  v_perm_b32 v61, v235, v167, v6
  s_waitcnt vmcnt(10)
  v_mov_b32_dpp v232, v168 row_ror:8 row_mask:0xf bank_mask:0xf
  v_perm_b32 v50, v232, v168, v6
  v_mfma_f32_32x32x16_bf16 a[32:47], v[68:71], a[108:111], a[32:47]
  v_permlane16_swap_b32 v57, v61
  v_mov_b32_dpp v233, v169 row_ror:8 row_mask:0xf bank_mask:0xf
  v_perm_b32 v54, v233, v169, v6
  v_mov_b32_dpp v234, v170 row_ror:8 row_mask:0xf bank_mask:0xf
  v_perm_b32 v58, v234, v170, v6
  v_mov_b32_dpp v235, v171 row_ror:8 row_mask:0xf bank_mask:0xf
  v_mfma_f32_32x32x16_bf16 a[48:63], v[76:79], a[108:111], a[48:63]
  ds_read_b128 a[108:111], v25 offset:16
  v_permlane16_swap_b32 v50, v54
  v_perm_b32 v62, v235, v171, v6
  v_mov_b32_dpp v232, v172 row_ror:8 row_mask:0xf bank_mask:0xf
  v_perm_b32 v51, v232, v172, v6
  s_waitcnt lgkmcnt(5)
  v_mfma_f32_32x32x16_bf16 a[64:79], v[64:67], a[112:115], a[64:79]
  buffer_load_dwordx4 v[104:107], v5, s[36:39], s6 offen
  v_permlane16_swap_b32 v58, v62
  v_mov_b32_dpp v233, v173 row_ror:8 row_mask:0xf bank_mask:0xf
  v_perm_b32 v55, v233, v173, v6
  v_mov_b32_dpp v234, v174 row_ror:8 row_mask:0xf bank_mask:0xf
  v_perm_b32 v59, v234, v174, v6
  v_mfma_f32_32x32x16_bf16 a[80:95], v[72:75], a[112:115], a[80:95]
  ds_read_b128 a[112:115], v33
  v_mov_b32_dpp v235, v175 row_ror:8 row_mask:0xf bank_mask:0xf
  v_permlane16_swap_b32 v51, v55
  v_perm_b32 v63, v235, v175, v6
  v_mfma_f32_32x32x16_bf16 a[64:79], v[68:71], a[116:119], a[64:79]
  s_nop 1
  v_permlane16_swap_b32 v59, v63
  v_mfma_f32_32x32x16_bf16 a[80:95], v[76:79], a[116:119], a[80:95]
  ds_read_b128 a[116:119], v33 offset:16
  s_add_u32 s47, s41, 32896
  s_add_u32 m0, s40, 73824
  s_nop 0
  buffer_load_dwordx4 v10, s[32:35], s47 offen offset:2080 lds
  buffer_load_dwordx4 a[168:171], v10, s[32:35], s47 offen offset:2144
  v_mfma_f32_32x32x16_bf16 v[176:191], v[64:67], a[120:123], v[176:191]
  buffer_load_dwordx4 v[108:111], v5, s[36:39], s6 offen offset:2048
  ds_write_b128 v248, a[196:199] offset:1040
  v_mfma_f32_32x32x16_bf16 v[192:207], v[72:75], a[120:123], v[192:207]
  ds_read_b128 a[120:123], v41
  v_mfma_f32_32x32x16_bf16 v[176:191], v[68:71], a[124:127], v[176:191]
  v_mfma_f32_32x32x16_bf16 v[192:207], v[76:79], a[124:127], v[192:207]
  ds_read_b128 a[124:127], v41 offset:16
  s_waitcnt lgkmcnt(5)
  v_mfma_f32_32x32x16_bf16 a[0:15], v[48:51], a[96:99], a[0:15]
  s_mov_b32 s6, 557056
  buffer_load_dwordx4 v[112:115], v4, s[36:39], s6 offen
  s_waitcnt vmcnt(13)
  v_mov_b32_dpp v232, v80 row_ror:8 row_mask:0xf bank_mask:0xf
  v_perm_b32 v128, v232, v80, v6
  v_mov_b32_dpp v233, v81 row_ror:8 row_mask:0xf bank_mask:0xf
  v_perm_b32 v132, v233, v81, v6
  v_mfma_f32_32x32x16_bf16 a[16:31], v[56:59], a[96:99], a[16:31]
  ds_read_b128 a[96:99], v18
  v_mov_b32_dpp v234, v82 row_ror:8 row_mask:0xf bank_mask:0xf
  v_perm_b32 v136, v234, v82, v6
  v_mov_b32_dpp v235, v83 row_ror:8 row_mask:0xf bank_mask:0xf
  v_permlane16_swap_b32 v128, v132
  v_mfma_f32_32x32x16_bf16 a[0:15], v[52:55], a[100:103], a[0:15]
  v_perm_b32 v140, v235, v83, v6
  v_mov_b32_dpp v232, v84 row_ror:8 row_mask:0xf bank_mask:0xf
  v_perm_b32 v129, v232, v84, v6
  v_permlane16_swap_b32 v136, v140
  v_mov_b32_dpp v233, v85 row_ror:8 row_mask:0xf bank_mask:0xf
  v_mfma_f32_32x32x16_bf16 a[16:31], v[60:63], a[100:103], a[16:31]
  ds_read_b128 a[100:103], v18 offset:16
  v_perm_b32 v133, v233, v85, v6
  v_mov_b32_dpp v234, v86 row_ror:8 row_mask:0xf bank_mask:0xf
  v_perm_b32 v137, v234, v86, v6
  v_mov_b32_dpp v235, v87 row_ror:8 row_mask:0xf bank_mask:0xf
  v_mfma_f32_32x32x16_bf16 a[32:47], v[48:51], a[104:107], a[32:47]
  buffer_load_dwordx4 v[116:119], v4, s[36:39], s6 offen offset:2048
  ds_write_b128 v248, a[200:203] offset:2080
  v_mfma_f32_32x32x16_bf16 a[48:63], v[56:59], a[104:107], a[48:63]
  ds_read_b128 a[104:107], v26
  v_permlane16_swap_b32 v129, v133
  v_perm_b32 v141, v235, v87, v6
  s_waitcnt vmcnt(10)
  v_mov_b32_dpp v232, v88 row_ror:8 row_mask:0xf bank_mask:0xf
  v_perm_b32 v130, v232, v88, v6
  v_mfma_f32_32x32x16_bf16 a[32:47], v[52:55], a[108:111], a[32:47]
  v_permlane16_swap_b32 v137, v141
  v_mov_b32_dpp v233, v89 row_ror:8 row_mask:0xf bank_mask:0xf
  v_perm_b32 v134, v233, v89, v6
  v_mov_b32_dpp v234, v90 row_ror:8 row_mask:0xf bank_mask:0xf
  v_perm_b32 v138, v234, v90, v6
  v_mfma_f32_32x32x16_bf16 a[48:63], v[60:63], a[108:111], a[48:63]
  ds_read_b128 a[108:111], v26 offset:16
  v_mov_b32_dpp v235, v91 row_ror:8 row_mask:0xf bank_mask:0xf
  v_permlane16_swap_b32 v130, v134
  v_perm_b32 v142, v235, v91, v6
  s_waitcnt lgkmcnt(5)
  v_mfma_f32_32x32x16_bf16 a[64:79], v[48:51], a[112:115], a[64:79]
  buffer_load_dwordx4 v[120:123], v5, s[36:39], s6 offen
  v_mov_b32_dpp v232, v92 row_ror:8 row_mask:0xf bank_mask:0xf
  v_perm_b32 v131, v232, v92, v6
  v_permlane16_swap_b32 v138, v142
  v_mov_b32_dpp v233, v93 row_ror:8 row_mask:0xf bank_mask:0xf
  v_mfma_f32_32x32x16_bf16 a[80:95], v[56:59], a[112:115], a[80:95]
  ds_read_b128 a[112:115], v34
  v_perm_b32 v135, v233, v93, v6
  v_mov_b32_dpp v234, v94 row_ror:8 row_mask:0xf bank_mask:0xf
  v_perm_b32 v139, v234, v94, v6
  v_mov_b32_dpp v235, v95 row_ror:8 row_mask:0xf bank_mask:0xf
  v_mfma_f32_32x32x16_bf16 a[64:79], v[52:55], a[116:119], a[64:79]
  s_add_u32 s47, s41, 32896
  s_add_u32 m0, s40, 73824
  s_nop 0
  buffer_load_dwordx4 v11, s[32:35], s47 offen offset:3120 lds
  buffer_load_dwordx4 a[172:175], v11, s[32:35], s47 offen offset:3184
  v_mfma_f32_32x32x16_bf16 a[80:95], v[60:63], a[116:119], a[80:95]
  ds_read_b128 a[116:119], v34 offset:16
  v_permlane16_swap_b32 v131, v135
  v_perm_b32 v143, v235, v95, v6
  v_mfma_f32_32x32x16_bf16 v[176:191], v[48:51], a[120:123], v[176:191]
  buffer_load_dwordx4 v[124:127], v5, s[36:39], s6 offen offset:2048
  ds_write_b128 v248, a[204:207] offset:3120
  v_mfma_f32_32x32x16_bf16 v[192:207], v[56:59], a[120:123], v[192:207]
  ds_read_b128 a[120:123], v42
  s_nop 1
  v_permlane16_swap_b32 v139, v143
  v_mfma_f32_32x32x16_bf16 v[176:191], v[52:55], a[124:127], v[176:191]
  v_mfma_f32_32x32x16_bf16 v[192:207], v[60:63], a[124:127], v[192:207]
  ds_read_b128 a[124:127], v42 offset:16
  s_waitcnt lgkmcnt(5)
  v_mfma_f32_32x32x16_bf16 a[0:15], v[128:131], a[96:99], a[0:15]
  s_mov_b32 s6, 688128
  buffer_load_dwordx4 v[160:163], v4, s[36:39], s6 offen
  s_waitcnt vmcnt(11)
  v_mov_b32_dpp v232, v96 row_ror:8 row_mask:0xf bank_mask:0xf
  v_perm_b32 v144, v232, v96, v6
  v_mov_b32_dpp v233, v97 row_ror:8 row_mask:0xf bank_mask:0xf
  v_perm_b32 v148, v233, v97, v6
  v_mov_b32_dpp v234, v98 row_ror:8 row_mask:0xf bank_mask:0xf
  v_mfma_f32_32x32x16_bf16 a[16:31], v[136:139], a[96:99], a[16:31]
  ds_read_b128 a[96:99], v19
  v_perm_b32 v152, v234, v98, v6
  v_mov_b32_dpp v235, v99 row_ror:8 row_mask:0xf bank_mask:0xf
  v_permlane16_swap_b32 v144, v148
  v_perm_b32 v156, v235, v99, v6
  v_mov_b32_dpp v232, v100 row_ror:8 row_mask:0xf bank_mask:0xf
  v_mfma_f32_32x32x16_bf16 a[0:15], v[132:135], a[100:103], a[0:15]
  v_perm_b32 v145, v232, v100, v6
  v_permlane16_swap_b32 v152, v156
  v_mov_b32_dpp v233, v101 row_ror:8 row_mask:0xf bank_mask:0xf
  v_perm_b32 v149, v233, v101, v6
  v_mov_b32_dpp v234, v102 row_ror:8 row_mask:0xf bank_mask:0xf
  v_perm_b32 v153, v234, v102, v6
  v_mfma_f32_32x32x16_bf16 a[16:31], v[140:143], a[100:103], a[16:31]
  ds_read_b128 a[100:103], v19 offset:16
  s_add_u32 s47, s41, 49280
  s_add_u32 m0, s40, 77984
  s_nop 0
  buffer_load_dwordx4 v8, s[32:35], s47 offen lds
  buffer_load_dwordx4 a[176:179], v8, s[32:35], s47 offen offset:64
  v_mov_b32_dpp v235, v103 row_ror:8 row_mask:0xf bank_mask:0xf
  v_mfma_f32_32x32x16_bf16 a[32:47], v[128:131], a[104:107], a[32:47]
  buffer_load_dwordx4 v[164:167], v4, s[36:39], s6 offen offset:2048
  ds_write_b128 v248, a[208:211] offset:4160
  v_mfma_f32_32x32x16_bf16 a[48:63], v[136:139], a[104:107], a[48:63]
  ds_read_b128 a[104:107], v27
  v_permlane16_swap_b32 v145, v149
  v_perm_b32 v157, v235, v103, v6
  s_waitcnt vmcnt(10)
  v_mov_b32_dpp v232, v104 row_ror:8 row_mask:0xf bank_mask:0xf
  v_perm_b32 v146, v232, v104, v6
  v_mfma_f32_32x32x16_bf16 a[32:47], v[132:135], a[108:111], a[32:47]
  v_permlane16_swap_b32 v153, v157
  v_mov_b32_dpp v233, v105 row_ror:8 row_mask:0xf bank_mask:0xf
  v_perm_b32 v150, v233, v105, v6
  v_mov_b32_dpp v234, v106 row_ror:8 row_mask:0xf bank_mask:0xf
  v_perm_b32 v154, v234, v106, v6
  v_mov_b32_dpp v235, v107 row_ror:8 row_mask:0xf bank_mask:0xf
  v_mfma_f32_32x32x16_bf16 a[48:63], v[140:143], a[108:111], a[48:63]
  ds_read_b128 a[108:111], v27 offset:16
  v_permlane16_swap_b32 v146, v150
  v_perm_b32 v158, v235, v107, v6
  v_mov_b32_dpp v232, v108 row_ror:8 row_mask:0xf bank_mask:0xf
  v_perm_b32 v147, v232, v108, v6
  s_waitcnt lgkmcnt(5)
  v_mfma_f32_32x32x16_bf16 a[64:79], v[128:131], a[112:115], a[64:79]
  buffer_load_dwordx4 v[168:171], v5, s[36:39], s6 offen
  v_permlane16_swap_b32 v154, v158
  v_mov_b32_dpp v233, v109 row_ror:8 row_mask:0xf bank_mask:0xf
  v_perm_b32 v151, v233, v109, v6
  v_mov_b32_dpp v234, v110 row_ror:8 row_mask:0xf bank_mask:0xf
  v_perm_b32 v155, v234, v110, v6
  v_mfma_f32_32x32x16_bf16 a[80:95], v[136:139], a[112:115], a[80:95]
  ds_read_b128 a[112:115], v35
  v_mov_b32_dpp v235, v111 row_ror:8 row_mask:0xf bank_mask:0xf
  v_permlane16_swap_b32 v147, v151
  v_perm_b32 v159, v235, v111, v6
  v_mfma_f32_32x32x16_bf16 a[64:79], v[132:135], a[116:119], a[64:79]
  s_nop 1
  v_permlane16_swap_b32 v155, v159
  v_mfma_f32_32x32x16_bf16 a[80:95], v[140:143], a[116:119], a[80:95]
  ds_read_b128 a[116:119], v35 offset:16
  s_add_u32 s47, s41, 49280
  s_add_u32 m0, s40, 77984
  s_nop 0
  buffer_load_dwordx4 v9, s[32:35], s47 offen offset:1040 lds
  buffer_load_dwordx4 a[180:183], v9, s[32:35], s47 offen offset:1104
  v_mfma_f32_32x32x16_bf16 v[176:191], v[128:131], a[120:123], v[176:191]
  buffer_load_dwordx4 v[172:175], v5, s[36:39], s6 offen offset:2048
  ds_write_b128 v248, a[212:215] offset:5200
  v_mfma_f32_32x32x16_bf16 v[192:207], v[136:139], a[120:123], v[192:207]
  ds_read_b128 a[120:123], v43
  v_mfma_f32_32x32x16_bf16 v[176:191], v[132:135], a[124:127], v[176:191]
  s_cmp_eq_u32 s46, 0
  s_cbranch_scc1 L_NOF
  s_waitcnt vmcnt(37)
  s_lshl_b32 s43, s5, 2
  v_mov_b32 v243, s43
  v_mov_b32 v244, 1
  s_mov_b64 exec, 1
  global_store_dword v243, v244, s[24:25] offset:128 sc0 sc1
  s_mov_b64 exec, -1
L_NOF:
  v_mfma_f32_32x32x16_bf16 v[192:207], v[140:143], a[124:127], v[192:207]
  ds_read_b128 a[124:127], v43 offset:16
  s_waitcnt lgkmcnt(5)
  v_mfma_f32_32x32x16_bf16 a[0:15], v[144:147], a[96:99], a[0:15]
  s_mov_b32 s6, 65536
  buffer_load_dwordx4 v[80:83], v4, s[36:39], s6 offen
  s_waitcnt vmcnt(13)
  v_mov_b32_dpp v232, v112 row_ror:8 row_mask:0xf bank_mask:0xf
  v_perm_b32 v64, v232, v112, v6
  v_mov_b32_dpp v233, v113 row_ror:8 row_mask:0xf bank_mask:0xf
  v_perm_b32 v68, v233, v113, v6
  v_mfma_f32_32x32x16_bf16 a[16:31], v[152:155], a[96:99], a[16:31]
  ds_read_b128 a[96:99], v20
  v_mov_b32_dpp v234, v114 row_ror:8 row_mask:0xf bank_mask:0xf
  v_perm_b32 v72, v234, v114, v6
  v_mov_b32_dpp v235, v115 row_ror:8 row_mask:0xf bank_mask:0xf
  v_permlane16_swap_b32 v64, v68
  v_mfma_f32_32x32x16_bf16 a[0:15], v[148:151], a[100:103], a[0:15]
  v_perm_b32 v76, v235, v115, v6
  v_mov_b32_dpp v232, v116 row_ror:8 row_mask:0xf bank_mask:0xf
  v_perm_b32 v65, v232, v116, v6
  v_permlane16_swap_b32 v72, v76
  v_mov_b32_dpp v233, v117 row_ror:8 row_mask:0xf bank_mask:0xf
  v_mfma_f32_32x32x16_bf16 a[16:31], v[156:159], a[100:103], a[16:31]
  ds_read_b128 a[100:103], v20 offset:16
  v_perm_b32 v69, v233, v117, v6
  v_mov_b32_dpp v234, v118 row_ror:8 row_mask:0xf bank_mask:0xf
  v_perm_b32 v73, v234, v118, v6
  v_mov_b32_dpp v235, v119 row_ror:8 row_mask:0xf bank_mask:0xf
  v_mfma_f32_32x32x16_bf16 a[32:47], v[144:147], a[104:107], a[32:47]
  buffer_load_dwordx4 v[84:87], v4, s[36:39], s6 offen offset:2048
  ds_write_b128 v248, a[216:219] offset:6240
  v_mfma_f32_32x32x16_bf16 a[48:63], v[152:155], a[104:107], a[48:63]
  ds_read_b128 a[104:107], v28
  v_permlane16_swap_b32 v65, v69
  v_perm_b32 v77, v235, v119, v6
  s_waitcnt vmcnt(10)
  v_mov_b32_dpp v232, v120 row_ror:8 row_mask:0xf bank_mask:0xf
  v_perm_b32 v66, v232, v120, v6
  v_mfma_f32_32x32x16_bf16 a[32:47], v[148:151], a[108:111], a[32:47]
  v_permlane16_swap_b32 v73, v77
  v_mov_b32_dpp v233, v121 row_ror:8 row_mask:0xf bank_mask:0xf
  v_perm_b32 v70, v233, v121, v6
  v_mov_b32_dpp v234, v122 row_ror:8 row_mask:0xf bank_mask:0xf
  v_perm_b32 v74, v234, v122, v6
  v_mfma_f32_32x32x16_bf16 a[48:63], v[156:159], a[108:111], a[48:63]
  ds_read_b128 a[108:111], v28 offset:16
  v_mov_b32_dpp v235, v123 row_ror:8 row_mask:0xf bank_mask:0xf
  v_permlane16_swap_b32 v66, v70
  v_perm_b32 v78, v235, v123, v6
  s_waitcnt lgkmcnt(5)
  v_mfma_f32_32x32x16_bf16 a[64:79], v[144:147], a[112:115], a[64:79]
  buffer_load_dwordx4 v[88:91], v5, s[36:39], s6 offen
  v_mov_b32_dpp v232, v124 row_ror:8 row_mask:0xf bank_mask:0xf
  v_perm_b32 v67, v232, v124, v6
  v_permlane16_swap_b32 v74, v78
  v_mov_b32_dpp v233, v125 row_ror:8 row_mask:0xf bank_mask:0xf
  v_mfma_f32_32x32x16_bf16 a[80:95], v[152:155], a[112:115], a[80:95]
  ds_read_b128 a[112:115], v36
  v_perm_b32 v71, v233, v125, v6
  v_mov_b32_dpp v234, v126 row_ror:8 row_mask:0xf bank_mask:0xf
  v_perm_b32 v75, v234, v126, v6
  v_mov_b32_dpp v235, v127 row_ror:8 row_mask:0xf bank_mask:0xf
  v_mfma_f32_32x32x16_bf16 a[64:79], v[148:151], a[116:119], a[64:79]
  s_add_u32 s47, s41, 49280
  s_add_u32 m0, s40, 77984
  s_nop 0
  buffer_load_dwordx4 v10, s[32:35], s47 offen offset:2080 lds
  buffer_load_dwordx4 a[184:187], v10, s[32:35], s47 offen offset:2144
  v_mfma_f32_32x32x16_bf16 a[80:95], v[156:159], a[116:119], a[80:95]
  ds_read_b128 a[116:119], v36 offset:16
  v_permlane16_swap_b32 v67, v71
  v_perm_b32 v79, v235, v127, v6
  v_mfma_f32_32x32x16_bf16 v[176:191], v[144:147], a[120:123], v[176:191]
  buffer_load_dwordx4 v[92:95], v5, s[36:39], s6 offen offset:2048
  ds_write_b128 v248, a[220:223] offset:7280
  v_mfma_f32_32x32x16_bf16 v[192:207], v[152:155], a[120:123], v[192:207]
  ds_read_b128 a[120:123], v44
  s_nop 1
  v_permlane16_swap_b32 v75, v79
  v_mfma_f32_32x32x16_bf16 v[176:191], v[148:151], a[124:127], v[176:191]
  v_mfma_f32_32x32x16_bf16 v[192:207], v[156:159], a[124:127], v[192:207]
  ds_read_b128 a[124:127], v44 offset:16
  s_waitcnt lgkmcnt(5)
  v_mfma_f32_32x32x16_bf16 a[0:15], v[64:67], a[96:99], a[0:15]
  s_mov_b32 s6, 196608
  buffer_load_dwordx4 v[96:99], v4, s[36:39], s6 offen
  s_waitcnt vmcnt(11)
  v_mov_b32_dpp v232, v160 row_ror:8 row_mask:0xf bank_mask:0xf
  v_perm_b32 v48, v232, v160, v6
  v_mov_b32_dpp v233, v161 row_ror:8 row_mask:0xf bank_mask:0xf
  v_perm_b32 v52, v233, v161, v6
  v_mfma_f32_32x32x16_bf16 a[16:31], v[72:75], a[96:99], a[16:31]
  ds_read_b128 a[96:99], v21
  s_add_u32 s47, s41, 49280
  s_add_u32 m0, s40, 77984
  s_nop 0
  buffer_load_dwordx4 v11, s[32:35], s47 offen offset:3120 lds
  buffer_load_dwordx4 a[188:191], v11, s[32:35], s47 offen offset:3184
  v_mfma_f32_32x32x16_bf16 a[0:15], v[68:71], a[100:103], a[0:15]
  v_mov_b32_dpp v234, v162 row_ror:8 row_mask:0xf bank_mask:0xf
  v_perm_b32 v56, v234, v162, v6
  v_mov_b32_dpp v235, v163 row_ror:8 row_mask:0xf bank_mask:0xf
  v_permlane16_swap_b32 v48, v52
  v_perm_b32 v60, v235, v163, v6
  v_mfma_f32_32x32x16_bf16 a[16:31], v[76:79], a[100:103], a[16:31]
  ds_read_b128 a[100:103], v21 offset:16
  buffer_load_dwordx4 v[100:103], v4, s[36:39], s6 offen offset:2048
  v_mov_b32_dpp v232, v164 row_ror:8 row_mask:0xf bank_mask:0xf
  v_perm_b32 v49, v232, v164, v6
  v_permlane16_swap_b32 v56, v60
  v_mfma_f32_32x32x16_bf16 a[32:47], v[64:67], a[104:107], a[32:47]
  ds_write_b128 v248, a[224:227] offset:8320
  v_mov_b32_dpp v233, v165 row_ror:8 row_mask:0xf bank_mask:0xf
  v_mfma_f32_32x32x16_bf16 a[48:63], v[72:75], a[104:107], a[48:63]
  ds_read_b128 a[104:107], v29
  v_perm_b32 v53, v233, v165, v6
  v_mov_b32_dpp v234, v166 row_ror:8 row_mask:0xf bank_mask:0xf
  v_perm_b32 v57, v234, v166, v6
  v_mov_b32_dpp v235, v167 row_ror:8 row_mask:0xf bank_mask:0xf
  v_mfma_f32_32x32x16_bf16 a[32:47], v[68:71], a[108:111], a[32:47]
  buffer_load_dwordx4 v[104:107], v5, s[36:39], s6 offen
  v_permlane16_swap_b32 v49, v53
  v_perm_b32 v61, v235, v167, v6
  s_waitcnt vmcnt(11)
  v_mov_b32_dpp v232, v168 row_ror:8 row_mask:0xf bank_mask:0xf
  v_perm_b32 v50, v232, v168, v6
  v_mfma_f32_32x32x16_bf16 a[48:63], v[76:79], a[108:111], a[48:63]
  ds_read_b128 a[108:111], v29 offset:16
  v_permlane16_swap_b32 v57, v61
  v_mov_b32_dpp v233, v169 row_ror:8 row_mask:0xf bank_mask:0xf
  v_perm_b32 v54, v233, v169, v6
  s_waitcnt lgkmcnt(5)
  v_mfma_f32_32x32x16_bf16 a[64:79], v[64:67], a[112:115], a[64:79]
  v_mov_b32_dpp v234, v170 row_ror:8 row_mask:0xf bank_mask:0xf
  v_perm_b32 v58, v234, v170, v6
  v_mov_b32_dpp v235, v171 row_ror:8 row_mask:0xf bank_mask:0xf
  v_permlane16_swap_b32 v50, v54
  v_perm_b32 v62, v235, v171, v6
  v_mfma_f32_32x32x16_bf16 a[80:95], v[72:75], a[112:115], a[80:95]
  ds_read_b128 a[112:115], v37
  buffer_load_dwordx4 v[108:111], v5, s[36:39], s6 offen offset:2048
  v_mov_b32_dpp v232, v172 row_ror:8 row_mask:0xf bank_mask:0xf
  v_perm_b32 v51, v232, v172, v6
  v_permlane16_swap_b32 v58, v62
  v_mfma_f32_32x32x16_bf16 a[64:79], v[68:71], a[116:119], a[64:79]
  s_mov_b32 s6, 327680
  buffer_load_dwordx4 v[128:131], v4, s[36:39], s6 offen
  v_mov_b32_dpp v233, v173 row_ror:8 row_mask:0xf bank_mask:0xf
  v_perm_b32 v55, v233, v173, v6
  v_mov_b32_dpp v234, v174 row_ror:8 row_mask:0xf bank_mask:0xf
  v_perm_b32 v59, v234, v174, v6
  v_mfma_f32_32x32x16_bf16 a[80:95], v[76:79], a[116:119], a[80:95]
  ds_read_b128 a[116:119], v37 offset:16
  v_mov_b32_dpp v235, v175 row_ror:8 row_mask:0xf bank_mask:0xf
  v_permlane16_swap_b32 v51, v55
  v_perm_b32 v63, v235, v175, v6
  v_mfma_f32_32x32x16_bf16 v[176:191], v[64:67], a[120:123], v[176:191]
  s_nop 1
  v_permlane16_swap_b32 v59, v63
  v_mfma_f32_32x32x16_bf16 v[192:207], v[72:75], a[120:123], v[192:207]
  ds_read_b128 a[120:123], v45
  buffer_load_dwordx4 v[132:135], v4, s[36:39], s6 offen offset:2048
  v_mfma_f32_32x32x16_bf16 v[176:191], v[68:71], a[124:127], v[176:191]
  v_mfma_f32_32x32x16_bf16 v[192:207], v[76:79], a[124:127], v[192:207]
  ds_read_b128 a[124:127], v45 offset:16
  s_waitcnt lgkmcnt(4)
  v_mfma_f32_32x32x16_bf16 a[0:15], v[48:51], a[96:99], a[0:15]
  buffer_load_dwordx4 v[136:139], v5, s[36:39], s6 offen
  s_waitcnt vmcnt(13)
  v_mov_b32_dpp v232, v80 row_ror:8 row_mask:0xf bank_mask:0xf
  v_perm_b32 v112, v232, v80, v6
  v_mov_b32_dpp v233, v81 row_ror:8 row_mask:0xf bank_mask:0xf
  v_perm_b32 v116, v233, v81, v6
  v_mov_b32_dpp v234, v82 row_ror:8 row_mask:0xf bank_mask:0xf
  v_perm_b32 v120, v234, v82, v6
  v_mfma_f32_32x32x16_bf16 a[16:31], v[56:59], a[96:99], a[16:31]
  v_mov_b32_dpp v235, v83 row_ror:8 row_mask:0xf bank_mask:0xf
  v_permlane16_swap_b32 v112, v116
  v_perm_b32 v124, v235, v83, v6
  v_mov_b32_dpp v232, v84 row_ror:8 row_mask:0xf bank_mask:0xf
  v_perm_b32 v113, v232, v84, v6
  v_mfma_f32_32x32x16_bf16 a[0:15], v[52:55], a[100:103], a[0:15]
  v_permlane16_swap_b32 v120, v124
  v_mov_b32_dpp v233, v85 row_ror:8 row_mask:0xf bank_mask:0xf
  v_perm_b32 v117, v233, v85, v6
  v_mov_b32_dpp v234, v86 row_ror:8 row_mask:0xf bank_mask:0xf
  v_perm_b32 v121, v234, v86, v6
  v_mov_b32_dpp v235, v87 row_ror:8 row_mask:0xf bank_mask:0xf
  v_mfma_f32_32x32x16_bf16 a[16:31], v[60:63], a[100:103], a[16:31]
  buffer_load_dwordx4 v[140:143], v5, s[36:39], s6 offen offset:2048
  v_permlane16_swap_b32 v113, v117
  v_perm_b32 v125, v235, v87, v6
  s_waitcnt vmcnt(8)
  s_waitcnt lgkmcnt(0)
  s_barrier
  v_mfma_f32_32x32x16_bf16 a[32:47], v[48:51], a[104:107], a[32:47]
  ds_read_b128 a[96:99], v16 offset:65504
  ds_read_b128 a[100:103], v16 offset:65520
  v_mov_b32_dpp v232, v88 row_ror:8 row_mask:0xf bank_mask:0xf
  v_perm_b32 v114, v232, v88, v6
  v_permlane16_swap_b32 v121, v125
  v_mov_b32_dpp v233, v89 row_ror:8 row_mask:0xf bank_mask:0xf
  v_mfma_f32_32x32x16_bf16 a[48:63], v[56:59], a[104:107], a[48:63]
  ds_read_b128 a[104:107], v24 offset:65504
  v_perm_b32 v118, v233, v89, v6
  v_mov_b32_dpp v234, v90 row_ror:8 row_mask:0xf bank_mask:0xf
  v_perm_b32 v122, v234, v90, v6
  v_mov_b32_dpp v235, v91 row_ror:8 row_mask:0xf bank_mask:0xf
  v_permlane16_swap_b32 v114, v118
  v_mfma_f32_32x32x16_bf16 a[32:47], v[52:55], a[108:111], a[32:47]
  s_mov_b32 s6, 458752
  buffer_load_dwordx4 v[144:147], v4, s[36:39], s6 offen
  v_perm_b32 v126, v235, v91, v6
  v_mov_b32_dpp v232, v92 row_ror:8 row_mask:0xf bank_mask:0xf
  v_perm_b32 v115, v232, v92, v6
  v_permlane16_swap_b32 v122, v126
  v_mfma_f32_32x32x16_bf16 a[48:63], v[60:63], a[108:111], a[48:63]
  ds_read_b128 a[108:111], v24 offset:65520
  ds_write_b128 v0, a[128:131]
  v_mov_b32_dpp v233, v93 row_ror:8 row_mask:0xf bank_mask:0xf
  v_perm_b32 v119, v233, v93, v6
  v_mfma_f32_32x32x16_bf16 a[64:79], v[48:51], a[112:115], a[64:79]
  v_mov_b32_dpp v234, v94 row_ror:8 row_mask:0xf bank_mask:0xf
  v_perm_b32 v123, v234, v94, v6
  v_mov_b32_dpp v235, v95 row_ror:8 row_mask:0xf bank_mask:0xf
  v_permlane16_swap_b32 v115, v119
  v_perm_b32 v127, v235, v95, v6
  v_mfma_f32_32x32x16_bf16 a[80:95], v[56:59], a[112:115], a[80:95]
  ds_read_b128 a[112:115], v32 offset:65504
  buffer_load_dwordx4 v[148:151], v4, s[36:39], s6 offen offset:2048
  s_nop 1
  v_permlane16_swap_b32 v123, v127
  v_mfma_f32_32x32x16_bf16 a[64:79], v[52:55], a[116:119], a[64:79]
  v_mfma_f32_32x32x16_bf16 a[80:95], v[60:63], a[116:119], a[80:95]
  ds_read_b128 a[116:119], v32 offset:65520
  ds_write_b128 v0, a[132:135] offset:1040
  v_mfma_f32_32x32x16_bf16 v[176:191], v[48:51], a[120:123], v[176:191]
  buffer_load_dwordx4 v[152:155], v5, s[36:39], s6 offen
  s_waitcnt vmcnt(9)
  v_mov_b32_dpp v232, v96 row_ror:8 row_mask:0xf bank_mask:0xf
  v_perm_b32 v160, v232, v96, v6
  v_mov_b32_dpp v233, v97 row_ror:8 row_mask:0xf bank_mask:0xf
  v_perm_b32 v164, v233, v97, v6
  v_mov_b32_dpp v234, v98 row_ror:8 row_mask:0xf bank_mask:0xf
  v_perm_b32 v168, v234, v98, v6
  v_mfma_f32_32x32x16_bf16 v[192:207], v[56:59], a[120:123], v[192:207]
  ds_read_b128 a[120:123], v40 offset:65504
  v_mov_b32_dpp v235, v99 row_ror:8 row_mask:0xf bank_mask:0xf
  v_permlane16_swap_b32 v160, v164
  v_perm_b32 v172, v235, v99, v6
  v_mov_b32_dpp v232, v100 row_ror:8 row_mask:0xf bank_mask:0xf
  v_perm_b32 v161, v232, v100, v6
  v_mfma_f32_32x32x16_bf16 v[176:191], v[52:55], a[124:127], v[176:191]
  v_permlane16_swap_b32 v168, v172
  v_mov_b32_dpp v233, v101 row_ror:8 row_mask:0xf bank_mask:0xf
  v_perm_b32 v165, v233, v101, v6
  v_mov_b32_dpp v234, v102 row_ror:8 row_mask:0xf bank_mask:0xf
  v_perm_b32 v169, v234, v102, v6
  v_mov_b32_dpp v235, v103 row_ror:8 row_mask:0xf bank_mask:0xf
  v_mfma_f32_32x32x16_bf16 v[192:207], v[60:63], a[124:127], v[192:207]
  ds_read_b128 a[124:127], v40 offset:65520
  buffer_load_dwordx4 v[156:159], v5, s[36:39], s6 offen offset:2048
  ds_write_b128 v0, a[136:139] offset:2080
  s_waitcnt lgkmcnt(7)
  v_mfma_f32_32x32x16_bf16 a[0:15], v[112:115], a[96:99], a[0:15]
  v_permlane16_swap_b32 v161, v165
  v_perm_b32 v173, v235, v103, v6
  s_waitcnt vmcnt(8)
  v_mov_b32_dpp v232, v104 row_ror:8 row_mask:0xf bank_mask:0xf
  v_perm_b32 v162, v232, v104, v6
  v_permlane16_swap_b32 v169, v173
  v_mfma_f32_32x32x16_bf16 a[16:31], v[120:123], a[96:99], a[16:31]
  ds_read_b128 a[96:99], v17 offset:65504
  v_mov_b32_dpp v233, v105 row_ror:8 row_mask:0xf bank_mask:0xf
  v_perm_b32 v166, v233, v105, v6
  v_mov_b32_dpp v234, v106 row_ror:8 row_mask:0xf bank_mask:0xf
  v_perm_b32 v170, v234, v106, v6
  v_mov_b32_dpp v235, v107 row_ror:8 row_mask:0xf bank_mask:0xf
  v_mfma_f32_32x32x16_bf16 a[0:15], v[116:119], a[100:103], a[0:15]
  s_mov_b32 s6, 589824
  buffer_load_dwordx4 v[64:67], v4, s[36:39], s6 offen
  v_permlane16_swap_b32 v162, v166
  v_perm_b32 v174, v235, v107, v6
  v_mov_b32_dpp v232, v108 row_ror:8 row_mask:0xf bank_mask:0xf
  v_perm_b32 v163, v232, v108, v6
  v_mfma_f32_32x32x16_bf16 a[16:31], v[124:127], a[100:103], a[16:31]
  ds_read_b128 a[100:103], v17 offset:65520
  s_add_u32 s52, s52, 0x8000
  buffer_load_dword v240, v251, s[36:39], s52 offen
  ds_write_b128 v0, a[140:143] offset:3120
  v_mfma_f32_32x32x16_bf16 a[32:47], v[112:115], a[104:107], a[32:47]
  v_permlane16_swap_b32 v170, v174
  v_mov_b32_dpp v233, v109 row_ror:8 row_mask:0xf bank_mask:0xf
  v_perm_b32 v167, v233, v109, v6
  v_mov_b32_dpp v234, v110 row_ror:8 row_mask:0xf bank_mask:0xf
  v_perm_b32 v171, v234, v110, v6
  v_mov_b32_dpp v235, v111 row_ror:8 row_mask:0xf bank_mask:0xf
  v_mfma_f32_32x32x16_bf16 a[48:63], v[120:123], a[104:107], a[48:63]
  ds_read_b128 a[104:107], v25 offset:65504
  buffer_load_dwordx4 v[68:71], v4, s[36:39], s6 offen offset:2048
  v_permlane16_swap_b32 v163, v167
  v_perm_b32 v175, v235, v111, v6
  v_mfma_f32_32x32x16_bf16 a[32:47], v[116:119], a[108:111], a[32:47]
  s_nop 1
  v_permlane16_swap_b32 v171, v175
  v_mfma_f32_32x32x16_bf16 a[48:63], v[124:127], a[108:111], a[48:63]
  ds_read_b128 a[108:111], v25 offset:65520
  ds_write_b128 v0, a[144:147] offset:4160
  s_waitcnt lgkmcnt(7)
  v_mfma_f32_32x32x16_bf16 a[64:79], v[112:115], a[112:115], a[64:79]
  buffer_load_dwordx4 v[72:75], v5, s[36:39], s6 offen
  s_waitcnt vmcnt(10)
  v_mov_b32_dpp v232, v128 row_ror:8 row_mask:0xf bank_mask:0xf
  v_perm_b32 v80, v232, v128, v6
  v_mov_b32_dpp v233, v129 row_ror:8 row_mask:0xf bank_mask:0xf
  v_perm_b32 v84, v233, v129, v6
  v_mov_b32_dpp v234, v130 row_ror:8 row_mask:0xf bank_mask:0xf
  v_mfma_f32_32x32x16_bf16 a[80:95], v[120:123], a[112:115], a[80:95]
  ds_read_b128 a[112:115], v33 offset:65504
  v_perm_b32 v88, v234, v130, v6
  v_mov_b32_dpp v235, v131 row_ror:8 row_mask:0xf bank_mask:0xf
  v_permlane16_swap_b32 v80, v84
  v_perm_b32 v92, v235, v131, v6
  v_mfma_f32_32x32x16_bf16 a[64:79], v[116:119], a[116:119], a[64:79]
  v_mov_b32_dpp v232, v132 row_ror:8 row_mask:0xf bank_mask:0xf
  v_perm_b32 v81, v232, v132, v6
  v_permlane16_swap_b32 v88, v92
  v_mov_b32_dpp v233, v133 row_ror:8 row_mask:0xf bank_mask:0xf
  v_perm_b32 v85, v233, v133, v6
  v_mfma_f32_32x32x16_bf16 a[80:95], v[124:127], a[116:119], a[80:95]
  ds_read_b128 a[116:119], v33 offset:65520
  buffer_load_dwordx4 v[76:79], v5, s[36:39], s6 offen offset:2048
  ds_write_b128 v0, a[148:151] offset:5200
  v_mfma_f32_32x32x16_bf16 v[176:191], v[112:115], a[120:123], v[176:191]
  v_mov_b32_dpp v234, v134 row_ror:8 row_mask:0xf bank_mask:0xf
  v_perm_b32 v89, v234, v134, v6
  v_mov_b32_dpp v235, v135 row_ror:8 row_mask:0xf bank_mask:0xf
  v_permlane16_swap_b32 v81, v85
  v_perm_b32 v93, v235, v135, v6
  v_mfma_f32_32x32x16_bf16 v[192:207], v[120:123], a[120:123], v[192:207]
  ds_read_b128 a[120:123], v41 offset:65504
  s_waitcnt vmcnt(9)
  v_mov_b32_dpp v232, v136 row_ror:8 row_mask:0xf bank_mask:0xf
  v_perm_b32 v82, v232, v136, v6
  v_permlane16_swap_b32 v89, v93
  v_mov_b32_dpp v233, v137 row_ror:8 row_mask:0xf bank_mask:0xf
  v_mfma_f32_32x32x16_bf16 v[176:191], v[116:119], a[124:127], v[176:191]
  s_mov_b32 s6, 720896
  buffer_load_dwordx4 v[48:51], v4, s[36:39], s6 offen
  v_perm_b32 v86, v233, v137, v6
  v_mov_b32_dpp v234, v138 row_ror:8 row_mask:0xf bank_mask:0xf
  v_perm_b32 v90, v234, v138, v6
  v_mov_b32_dpp v235, v139 row_ror:8 row_mask:0xf bank_mask:0xf
  v_mfma_f32_32x32x16_bf16 v[192:207], v[124:127], a[124:127], v[192:207]
  ds_read_b128 a[124:127], v41 offset:65520
  v_permlane16_swap_b32 v82, v86
  v_perm_b32 v94, v235, v139, v6
  v_mov_b32_dpp v232, v140 row_ror:8 row_mask:0xf bank_mask:0xf
  s_waitcnt lgkmcnt(6)
  v_mfma_f32_32x32x16_bf16 a[0:15], v[160:163], a[96:99], a[0:15]
  v_perm_b32 v83, v232, v140, v6
  v_permlane16_swap_b32 v90, v94
  v_mov_b32_dpp v233, v141 row_ror:8 row_mask:0xf bank_mask:0xf
  v_perm_b32 v87, v233, v141, v6
  v_mov_b32_dpp v234, v142 row_ror:8 row_mask:0xf bank_mask:0xf
  v_mfma_f32_32x32x16_bf16 a[16:31], v[168:171], a[96:99], a[16:31]
  ds_read_b128 a[96:99], v18 offset:65504
  buffer_load_dwordx4 v[52:55], v4, s[36:39], s6 offen offset:2048
  v_perm_b32 v91, v234, v142, v6
  v_mov_b32_dpp v235, v143 row_ror:8 row_mask:0xf bank_mask:0xf
  v_permlane16_swap_b32 v83, v87
  v_mfma_f32_32x32x16_bf16 a[0:15], v[164:167], a[100:103], a[0:15]
  v_perm_b32 v95, v235, v143, v6
  s_nop 1
  v_permlane16_swap_b32 v91, v95
  v_mfma_f32_32x32x16_bf16 a[16:31], v[172:175], a[100:103], a[16:31]
  ds_read_b128 a[100:103], v18 offset:65520
  ds_write_b128 v0, a[152:155] offset:6240
  v_mfma_f32_32x32x16_bf16 a[32:47], v[160:163], a[104:107], a[32:47]
  buffer_load_dwordx4 v[56:59], v5, s[36:39], s6 offen
  s_waitcnt vmcnt(10)
  v_mov_b32_dpp v232, v144 row_ror:8 row_mask:0xf bank_mask:0xf
  v_perm_b32 v96, v232, v144, v6
  v_mov_b32_dpp v233, v145 row_ror:8 row_mask:0xf bank_mask:0xf
  v_perm_b32 v100, v233, v145, v6
  v_mov_b32_dpp v234, v146 row_ror:8 row_mask:0xf bank_mask:0xf
  v_mfma_f32_32x32x16_bf16 a[48:63], v[168:171], a[104:107], a[48:63]
  ds_read_b128 a[104:107], v26 offset:65504
  v_perm_b32 v104, v234, v146, v6
  v_mov_b32_dpp v235, v147 row_ror:8 row_mask:0xf bank_mask:0xf
  v_permlane16_swap_b32 v96, v100
  v_perm_b32 v108, v235, v147, v6
  v_mfma_f32_32x32x16_bf16 a[32:47], v[164:167], a[108:111], a[32:47]
  v_mov_b32_dpp v232, v148 row_ror:8 row_mask:0xf bank_mask:0xf
  v_perm_b32 v97, v232, v148, v6
  v_permlane16_swap_b32 v104, v108
  v_mov_b32_dpp v233, v149 row_ror:8 row_mask:0xf bank_mask:0xf
  v_perm_b32 v101, v233, v149, v6
  v_mfma_f32_32x32x16_bf16 a[48:63], v[172:175], a[108:111], a[48:63]
  ds_read_b128 a[108:111], v26 offset:65520
  buffer_load_dwordx4 v[60:63], v5, s[36:39], s6 offen offset:2048
  ds_write_b128 v0, a[156:159] offset:7280
  s_waitcnt lgkmcnt(6)
  v_mfma_f32_32x32x16_bf16 a[64:79], v[160:163], a[112:115], a[64:79]
  v_mov_b32_dpp v234, v150 row_ror:8 row_mask:0xf bank_mask:0xf
  v_perm_b32 v105, v234, v150, v6
  v_mov_b32_dpp v235, v151 row_ror:8 row_mask:0xf bank_mask:0xf
  v_permlane16_swap_b32 v97, v101
  v_perm_b32 v109, v235, v151, v6
  v_mfma_f32_32x32x16_bf16 a[80:95], v[168:171], a[112:115], a[80:95]
  ds_read_b128 a[112:115], v34 offset:65504
  s_waitcnt vmcnt(9)
  v_mov_b32_dpp v232, v152 row_ror:8 row_mask:0xf bank_mask:0xf
  v_perm_b32 v98, v232, v152, v6
  v_permlane16_swap_b32 v105, v109
  v_mov_b32_dpp v233, v153 row_ror:8 row_mask:0xf bank_mask:0xf
  v_mfma_f32_32x32x16_bf16 a[64:79], v[164:167], a[116:119], a[64:79]
  s_add_u32 s6, s7, 65536
  buffer_load_dwordx4 v[112:115], v4, s[36:39], s6 offen
  v_perm_b32 v102, v233, v153, v6
  v_mov_b32_dpp v234, v154 row_ror:8 row_mask:0xf bank_mask:0xf
  v_perm_b32 v106, v234, v154, v6
  v_mov_b32_dpp v235, v155 row_ror:8 row_mask:0xf bank_mask:0xf
  v_mfma_f32_32x32x16_bf16 a[80:95], v[172:175], a[116:119], a[80:95]
  ds_read_b128 a[116:119], v34 offset:65520
  ds_write_b128 v0, a[160:163] offset:8320
  v_mfma_f32_32x32x16_bf16 v[176:191], v[160:163], a[120:123], v[176:191]
  v_permlane16_swap_b32 v98, v102
  v_perm_b32 v110, v235, v155, v6
  v_mov_b32_dpp v232, v156 row_ror:8 row_mask:0xf bank_mask:0xf
  v_perm_b32 v99, v232, v156, v6
  v_mfma_f32_32x32x16_bf16 v[192:207], v[168:171], a[120:123], v[192:207]
  ds_read_b128 a[120:123], v42 offset:65504
  buffer_load_dwordx4 v[116:119], v4, s[36:39], s6 offen offset:2048
  v_permlane16_swap_b32 v106, v110
  v_mov_b32_dpp v233, v157 row_ror:8 row_mask:0xf bank_mask:0xf
  v_perm_b32 v103, v233, v157, v6
  v_mfma_f32_32x32x16_bf16 v[176:191], v[164:167], a[124:127], v[176:191]
  v_mov_b32_dpp v234, v158 row_ror:8 row_mask:0xf bank_mask:0xf
  v_perm_b32 v107, v234, v158, v6
  v_mov_b32_dpp v235, v159 row_ror:8 row_mask:0xf bank_mask:0xf
  v_permlane16_swap_b32 v99, v103
  v_perm_b32 v111, v235, v159, v6
  v_mfma_f32_32x32x16_bf16 v[192:207], v[172:175], a[124:127], v[192:207]
  ds_read_b128 a[124:127], v42 offset:65520
  s_nop 1
  v_permlane16_swap_b32 v107, v111
  s_waitcnt lgkmcnt(6)
  v_mfma_f32_32x32x16_bf16 a[0:15], v[80:83], a[96:99], a[0:15]
  buffer_load_dwordx4 v[120:123], v5, s[36:39], s6 offen
  s_waitcnt vmcnt(9)
  v_mov_b32_dpp v232, v64 row_ror:8 row_mask:0xf bank_mask:0xf
  v_perm_b32 v128, v232, v64, v6
  v_mov_b32_dpp v233, v65 row_ror:8 row_mask:0xf bank_mask:0xf
  v_perm_b32 v132, v233, v65, v6
  v_mov_b32_dpp v234, v66 row_ror:8 row_mask:0xf bank_mask:0xf
  v_perm_b32 v136, v234, v66, v6
  v_mfma_f32_32x32x16_bf16 a[16:31], v[88:91], a[96:99], a[16:31]
  ds_read_b128 a[96:99], v19 offset:65504
  v_mov_b32_dpp v235, v67 row_ror:8 row_mask:0xf bank_mask:0xf
  v_permlane16_swap_b32 v128, v132
  v_perm_b32 v140, v235, v67, v6
  v_mov_b32_dpp v232, v68 row_ror:8 row_mask:0xf bank_mask:0xf
  v_perm_b32 v129, v232, v68, v6
  v_mfma_f32_32x32x16_bf16 a[0:15], v[84:87], a[100:103], a[0:15]
  v_permlane16_swap_b32 v136, v140
  v_mov_b32_dpp v233, v69 row_ror:8 row_mask:0xf bank_mask:0xf
  v_perm_b32 v133, v233, v69, v6
  v_mov_b32_dpp v234, v70 row_ror:8 row_mask:0xf bank_mask:0xf
  v_perm_b32 v137, v234, v70, v6
  v_mov_b32_dpp v235, v71 row_ror:8 row_mask:0xf bank_mask:0xf
  v_mfma_f32_32x32x16_bf16 a[16:31], v[92:95], a[100:103], a[16:31]
  ds_read_b128 a[100:103], v19 offset:65520
  buffer_load_dwordx4 v[124:127], v5, s[36:39], s6 offen offset:2048
  ds_write_b128 v0, a[164:167] offset:9360
  v_mfma_f32_32x32x16_bf16 a[32:47], v[80:83], a[104:107], a[32:47]
  v_permlane16_swap_b32 v129, v133
  v_perm_b32 v141, v235, v71, v6
  s_waitcnt vmcnt(8)
  v_mov_b32_dpp v232, v72 row_ror:8 row_mask:0xf bank_mask:0xf
  v_perm_b32 v130, v232, v72, v6
  v_permlane16_swap_b32 v137, v141
  v_mfma_f32_32x32x16_bf16 a[48:63], v[88:91], a[104:107], a[48:63]
  ds_read_b128 a[104:107], v27 offset:65504
  v_mov_b32_dpp v233, v73 row_ror:8 row_mask:0xf bank_mask:0xf
  v_perm_b32 v134, v233, v73, v6
  v_mov_b32_dpp v234, v74 row_ror:8 row_mask:0xf bank_mask:0xf
  v_perm_b32 v138, v234, v74, v6
  v_mov_b32_dpp v235, v75 row_ror:8 row_mask:0xf bank_mask:0xf
  v_mfma_f32_32x32x16_bf16 a[32:47], v[84:87], a[108:111], a[32:47]
  v_permlane16_swap_b32 v130, v134
  v_perm_b32 v142, v235, v75, v6
  v_mov_b32_dpp v232, v76 row_ror:8 row_mask:0xf bank_mask:0xf
  v_perm_b32 v131, v232, v76, v6
  v_permlane16_swap_b32 v138, v142
  v_mfma_f32_32x32x16_bf16 a[48:63], v[92:95], a[108:111], a[48:63]
  ds_read_b128 a[108:111], v27 offset:65520
  s_mov_b32 s6, 98304
  buffer_load_dwordx4 v[144:147], v4, s[36:39], s6 offen
  ds_write_b128 v0, a[168:171] offset:10400
  s_waitcnt lgkmcnt(6)
  v_mfma_f32_32x32x16_bf16 a[64:79], v[80:83], a[112:115], a[64:79]
  v_mov_b32_dpp v233, v77 row_ror:8 row_mask:0xf bank_mask:0xf
  v_perm_b32 v135, v233, v77, v6
  v_mov_b32_dpp v234, v78 row_ror:8 row_mask:0xf bank_mask:0xf
  v_perm_b32 v139, v234, v78, v6
  v_mov_b32_dpp v235, v79 row_ror:8 row_mask:0xf bank_mask:0xf
  v_permlane16_swap_b32 v131, v135
  v_mfma_f32_32x32x16_bf16 a[80:95], v[88:91], a[112:115], a[80:95]
  ds_read_b128 a[112:115], v35 offset:65504
  v_perm_b32 v143, v235, v79, v6
  s_nop 1
  v_permlane16_swap_b32 v139, v143
  v_mfma_f32_32x32x16_bf16 a[64:79], v[84:87], a[116:119], a[64:79]
  buffer_load_dwordx4 v[148:151], v4, s[36:39], s6 offen offset:2048
  v_mfma_f32_32x32x16_bf16 a[80:95], v[92:95], a[116:119], a[80:95]
  ds_read_b128 a[116:119], v35 offset:65520
  ds_write_b128 v0, a[172:175] offset:11440
  v_mfma_f32_32x32x16_bf16 v[176:191], v[80:83], a[120:123], v[176:191]
  s_waitcnt vmcnt(8)
  v_mov_b32_dpp v232, v48 row_ror:8 row_mask:0xf bank_mask:0xf
  v_perm_b32 v160, v232, v48, v6
  v_mov_b32_dpp v233, v49 row_ror:8 row_mask:0xf bank_mask:0xf
  v_perm_b32 v164, v233, v49, v6
  v_mov_b32_dpp v234, v50 row_ror:8 row_mask:0xf bank_mask:0xf
  v_perm_b32 v168, v234, v50, v6
  v_mfma_f32_32x32x16_bf16 v[192:207], v[88:91], a[120:123], v[192:207]
  ds_read_b128 a[120:123], v43 offset:65504
  buffer_load_dwordx4 v[152:155], v5, s[36:39], s6 offen
  v_mov_b32_dpp v235, v51 row_ror:8 row_mask:0xf bank_mask:0xf
  v_permlane16_swap_b32 v160, v164
  v_perm_b32 v172, v235, v51, v6
  v_mfma_f32_32x32x16_bf16 v[176:191], v[84:87], a[124:127], v[176:191]
  v_mov_b32_dpp v232, v52 row_ror:8 row_mask:0xf bank_mask:0xf
  v_perm_b32 v161, v232, v52, v6
  v_permlane16_swap_b32 v168, v172
  v_mov_b32_dpp v233, v53 row_ror:8 row_mask:0xf bank_mask:0xf
  v_perm_b32 v165, v233, v53, v6
  v_mfma_f32_32x32x16_bf16 v[192:207], v[92:95], a[124:127], v[192:207]
  ds_read_b128 a[124:127], v43 offset:65520
  v_mov_b32_dpp v234, v54 row_ror:8 row_mask:0xf bank_mask:0xf
  v_perm_b32 v169, v234, v54, v6
  v_mov_b32_dpp v235, v55 row_ror:8 row_mask:0xf bank_mask:0xf
  s_waitcnt lgkmcnt(6)
  v_mfma_f32_32x32x16_bf16 a[0:15], v[96:99], a[96:99], a[0:15]
  buffer_load_dwordx4 v[156:159], v5, s[36:39], s6 offen offset:2048
  v_permlane16_swap_b32 v161, v165
  v_perm_b32 v173, v235, v55, v6
  s_waitcnt vmcnt(8)
  v_mov_b32_dpp v232, v56 row_ror:8 row_mask:0xf bank_mask:0xf
  v_perm_b32 v162, v232, v56, v6
  v_mfma_f32_32x32x16_bf16 a[16:31], v[104:107], a[96:99], a[16:31]
  ds_read_b128 a[96:99], v20 offset:65504
  v_permlane16_swap_b32 v169, v173
  v_mov_b32_dpp v233, v57 row_ror:8 row_mask:0xf bank_mask:0xf
  v_perm_b32 v166, v233, v57, v6
  v_mov_b32_dpp v234, v58 row_ror:8 row_mask:0xf bank_mask:0xf
  v_mfma_f32_32x32x16_bf16 a[0:15], v[100:103], a[100:103], a[0:15]
  v_perm_b32 v170, v234, v58, v6
  v_mov_b32_dpp v235, v59 row_ror:8 row_mask:0xf bank_mask:0xf
  v_permlane16_swap_b32 v162, v166
  v_perm_b32 v174, v235, v59, v6
  v_mov_b32_dpp v232, v60 row_ror:8 row_mask:0xf bank_mask:0xf
  v_mfma_f32_32x32x16_bf16 a[16:31], v[108:111], a[100:103], a[16:31]
  ds_read_b128 a[100:103], v20 offset:65520
  s_mov_b32 s6, 229376
  buffer_load_dwordx4 v[64:67], v4, s[36:39], s6 offen
  ds_write_b128 v0, a[176:179] offset:12480
  v_mfma_f32_32x32x16_bf16 a[32:47], v[96:99], a[104:107], a[32:47]
  v_perm_b32 v163, v232, v60, v6
  v_permlane16_swap_b32 v170, v174
  v_mov_b32_dpp v233, v61 row_ror:8 row_mask:0xf bank_mask:0xf
  v_perm_b32 v167, v233, v61, v6
  v_mov_b32_dpp v234, v62 row_ror:8 row_mask:0xf bank_mask:0xf
  v_mfma_f32_32x32x16_bf16 a[48:63], v[104:107], a[104:107], a[48:63]
  ds_read_b128 a[104:107], v28 offset:65504
  v_perm_b32 v171, v234, v62, v6
  v_mov_b32_dpp v235, v63 row_ror:8 row_mask:0xf bank_mask:0xf
  v_permlane16_swap_b32 v163, v167
  v_perm_b32 v175, v235, v63, v6
  v_mfma_f32_32x32x16_bf16 a[32:47], v[100:103], a[108:111], a[32:47]
  buffer_load_dwordx4 v[68:71], v4, s[36:39], s6 offen offset:2048
  s_nop 1
  v_permlane16_swap_b32 v171, v175
  v_mfma_f32_32x32x16_bf16 a[48:63], v[108:111], a[108:111], a[48:63]
  ds_read_b128 a[108:111], v28 offset:65520
  ds_write_b128 v0, a[180:183] offset:13520
  s_waitcnt lgkmcnt(6)
  v_mfma_f32_32x32x16_bf16 a[64:79], v[96:99], a[112:115], a[64:79]
  s_waitcnt vmcnt(8)
  v_mov_b32_dpp v232, v112 row_ror:8 row_mask:0xf bank_mask:0xf
  v_perm_b32 v80, v232, v112, v6
  v_mov_b32_dpp v233, v113 row_ror:8 row_mask:0xf bank_mask:0xf
  v_perm_b32 v84, v233, v113, v6
  v_mov_b32_dpp v234, v114 row_ror:8 row_mask:0xf bank_mask:0xf
  v_perm_b32 v88, v234, v114, v6
  v_mfma_f32_32x32x16_bf16 a[80:95], v[104:107], a[112:115], a[80:95]
  ds_read_b128 a[112:115], v36 offset:65504
  buffer_load_dwordx4 v[72:75], v5, s[36:39], s6 offen
  v_mov_b32_dpp v235, v115 row_ror:8 row_mask:0xf bank_mask:0xf
  v_permlane16_swap_b32 v80, v84
  v_perm_b32 v92, v235, v115, v6
  v_mfma_f32_32x32x16_bf16 a[64:79], v[100:103], a[116:119], a[64:79]
  v_mov_b32_dpp v232, v116 row_ror:8 row_mask:0xf bank_mask:0xf
  v_perm_b32 v81, v232, v116, v6
  v_permlane16_swap_b32 v88, v92
  v_mov_b32_dpp v233, v117 row_ror:8 row_mask:0xf bank_mask:0xf
  v_perm_b32 v85, v233, v117, v6
  v_mfma_f32_32x32x16_bf16 a[80:95], v[108:111], a[116:119], a[80:95]
  ds_read_b128 a[116:119], v36 offset:65520
  ds_write_b128 v0, a[184:187] offset:14560
  v_mov_b32_dpp v234, v118 row_ror:8 row_mask:0xf bank_mask:0xf
  v_mfma_f32_32x32x16_bf16 v[176:191], v[96:99], a[120:123], v[176:191]
  buffer_load_dwordx4 v[76:79], v5, s[36:39], s6 offen offset:2048
  v_perm_b32 v89, v234, v118, v6
  v_mov_b32_dpp v235, v119 row_ror:8 row_mask:0xf bank_mask:0xf
  v_permlane16_swap_b32 v81, v85
  v_perm_b32 v93, v235, v119, v6
  v_mfma_f32_32x32x16_bf16 v[192:207], v[104:107], a[120:123], v[192:207]
  ds_read_b128 a[120:123], v44 offset:65504
  s_waitcnt vmcnt(8)
  v_mov_b32_dpp v232, v120 row_ror:8 row_mask:0xf bank_mask:0xf
  v_perm_b32 v82, v232, v120, v6
  v_permlane16_swap_b32 v89, v93
  v_mov_b32_dpp v233, v121 row_ror:8 row_mask:0xf bank_mask:0xf
  v_mfma_f32_32x32x16_bf16 v[176:191], v[100:103], a[124:127], v[176:191]
  v_perm_b32 v86, v233, v121, v6
  v_mov_b32_dpp v234, v122 row_ror:8 row_mask:0xf bank_mask:0xf
  v_perm_b32 v90, v234, v122, v6
  v_mov_b32_dpp v235, v123 row_ror:8 row_mask:0xf bank_mask:0xf
  v_permlane16_swap_b32 v82, v86
  v_mfma_f32_32x32x16_bf16 v[192:207], v[108:111], a[124:127], v[192:207]
  ds_read_b128 a[124:127], v44 offset:65520
  s_mov_b32 s6, 360448
  buffer_load_dwordx4 v[48:51], v4, s[36:39], s6 offen
  v_perm_b32 v94, v235, v123, v6
  v_mov_b32_dpp v232, v124 row_ror:8 row_mask:0xf bank_mask:0xf
  s_waitcnt lgkmcnt(6)
  v_mfma_f32_32x32x16_bf16 a[0:15], v[128:131], a[96:99], a[0:15]
  v_perm_b32 v83, v232, v124, v6
  v_permlane16_swap_b32 v90, v94
  v_mov_b32_dpp v233, v125 row_ror:8 row_mask:0xf bank_mask:0xf
  v_perm_b32 v87, v233, v125, v6
  v_mov_b32_dpp v234, v126 row_ror:8 row_mask:0xf bank_mask:0xf
  v_mfma_f32_32x32x16_bf16 a[16:31], v[136:139], a[96:99], a[16:31]
  ds_read_b128 a[96:99], v21 offset:65504
  v_perm_b32 v91, v234, v126, v6
  v_mov_b32_dpp v235, v127 row_ror:8 row_mask:0xf bank_mask:0xf
  v_permlane16_swap_b32 v83, v87
  v_perm_b32 v95, v235, v127, v6
  v_mfma_f32_32x32x16_bf16 a[0:15], v[132:135], a[100:103], a[0:15]
  buffer_load_dwordx4 v[52:55], v4, s[36:39], s6 offen offset:2048
  s_nop 1
  v_permlane16_swap_b32 v91, v95
  v_mfma_f32_32x32x16_bf16 a[16:31], v[140:143], a[100:103], a[16:31]
  ds_read_b128 a[100:103], v21 offset:65520
  ds_write_b128 v0, a[188:191] offset:15600
  v_mfma_f32_32x32x16_bf16 a[32:47], v[128:131], a[104:107], a[32:47]
  v_mfma_f32_32x32x16_bf16 a[48:63], v[136:139], a[104:107], a[48:63]
  ds_read_b128 a[104:107], v29 offset:65504
  buffer_load_dwordx4 v[56:59], v5, s[36:39], s6 offen
  s_waitcnt vmcnt(9)
  v_mov_b32_dpp v232, v144 row_ror:8 row_mask:0xf bank_mask:0xf
  v_perm_b32 v96, v232, v144, v6
  v_mov_b32_dpp v233, v145 row_ror:8 row_mask:0xf bank_mask:0xf
  v_perm_b32 v100, v233, v145, v6
  v_mfma_f32_32x32x16_bf16 a[32:47], v[132:135], a[108:111], a[32:47]
  v_mov_b32_dpp v234, v146 row_ror:8 row_mask:0xf bank_mask:0xf
  v_perm_b32 v104, v234, v146, v6
  v_mov_b32_dpp v235, v147 row_ror:8 row_mask:0xf bank_mask:0xf
  v_permlane16_swap_b32 v96, v100
  v_perm_b32 v108, v235, v147, v6
  v_mfma_f32_32x32x16_bf16 a[48:63], v[140:143], a[108:111], a[48:63]
  ds_read_b128 a[108:111], v29 offset:65520
  v_mov_b32_dpp v232, v148 row_ror:8 row_mask:0xf bank_mask:0xf
  v_perm_b32 v97, v232, v148, v6
  v_permlane16_swap_b32 v104, v108
  s_waitcnt lgkmcnt(5)
  v_mfma_f32_32x32x16_bf16 a[64:79], v[128:131], a[112:115], a[64:79]
  buffer_load_dwordx4 v[60:63], v5, s[36:39], s6 offen offset:2048
  v_mov_b32_dpp v233, v149 row_ror:8 row_mask:0xf bank_mask:0xf
  v_perm_b32 v101, v233, v149, v6
  v_mov_b32_dpp v234, v150 row_ror:8 row_mask:0xf bank_mask:0xf
  v_perm_b32 v105, v234, v150, v6
  v_mov_b32_dpp v235, v151 row_ror:8 row_mask:0xf bank_mask:0xf
  v_mfma_f32_32x32x16_bf16 a[80:95], v[136:139], a[112:115], a[80:95]
  ds_read_b128 a[112:115], v37 offset:65504
  v_permlane16_swap_b32 v97, v101
  v_perm_b32 v109, v235, v151, v6
  s_waitcnt vmcnt(8)
  v_mov_b32_dpp v232, v152 row_ror:8 row_mask:0xf bank_mask:0xf
  v_perm_b32 v98, v232, v152, v6
  v_mfma_f32_32x32x16_bf16 a[64:79], v[132:135], a[116:119], a[64:79]
  v_permlane16_swap_b32 v105, v109
  v_mov_b32_dpp v233, v153 row_ror:8 row_mask:0xf bank_mask:0xf
  v_perm_b32 v102, v233, v153, v6
  v_mov_b32_dpp v234, v154 row_ror:8 row_mask:0xf bank_mask:0xf
  v_perm_b32 v106, v234, v154, v6
  v_mfma_f32_32x32x16_bf16 a[80:95], v[140:143], a[116:119], a[80:95]
  ds_read_b128 a[116:119], v37 offset:65520
  s_mov_b32 s6, 491520
  buffer_load_dwordx4 v[112:115], v4, s[36:39], s6 offen
  v_mov_b32_dpp v235, v155 row_ror:8 row_mask:0xf bank_mask:0xf
  v_permlane16_swap_b32 v98, v102
  v_mfma_f32_32x32x16_bf16 v[176:191], v[128:131], a[120:123], v[176:191]
  v_perm_b32 v110, v235, v155, v6
  v_mov_b32_dpp v232, v156 row_ror:8 row_mask:0xf bank_mask:0xf
  v_perm_b32 v99, v232, v156, v6
  v_permlane16_swap_b32 v106, v110
  v_mov_b32_dpp v233, v157 row_ror:8 row_mask:0xf bank_mask:0xf
  v_mfma_f32_32x32x16_bf16 v[192:207], v[136:139], a[120:123], v[192:207]
  ds_read_b128 a[120:123], v45 offset:65504
  v_perm_b32 v103, v233, v157, v6
  v_mov_b32_dpp v234, v158 row_ror:8 row_mask:0xf bank_mask:0xf
  v_perm_b32 v107, v234, v158, v6
  v_mov_b32_dpp v235, v159 row_ror:8 row_mask:0xf bank_mask:0xf
  v_mfma_f32_32x32x16_bf16 v[176:191], v[132:135], a[124:127], v[176:191]
  buffer_load_dwordx4 v[116:119], v4, s[36:39], s6 offen offset:2048
  v_permlane16_swap_b32 v99, v103
  v_perm_b32 v111, v235, v159, v6
  v_mfma_f32_32x32x16_bf16 v[192:207], v[140:143], a[124:127], v[192:207]
  ds_read_b128 a[124:127], v45 offset:65520
  s_nop 1
  v_permlane16_swap_b32 v107, v111
  s_waitcnt lgkmcnt(4)
  v_mfma_f32_32x32x16_bf16 a[0:15], v[160:163], a[96:99], a[0:15]
  s_barrier
  v_mfma_f32_32x32x16_bf16 a[16:31], v[168:171], a[96:99], a[16:31]
  ds_read_b128 a[96:99], v22
  buffer_load_dwordx4 v[120:123], v5, s[36:39], s6 offen
  s_waitcnt vmcnt(9)
  v_mov_b32_dpp v232, v64 row_ror:8 row_mask:0xf bank_mask:0xf
  v_perm_b32 v128, v232, v64, v6
  v_mov_b32_dpp v233, v65 row_ror:8 row_mask:0xf bank_mask:0xf
  v_perm_b32 v132, v233, v65, v6
  v_mfma_f32_32x32x16_bf16 a[0:15], v[164:167], a[100:103], a[0:15]
  v_mov_b32_dpp v234, v66 row_ror:8 row_mask:0xf bank_mask:0xf
  v_perm_b32 v136, v234, v66, v6
  v_mov_b32_dpp v235, v67 row_ror:8 row_mask:0xf bank_mask:0xf
  v_permlane16_swap_b32 v128, v132
  v_perm_b32 v140, v235, v67, v6
  v_mfma_f32_32x32x16_bf16 a[16:31], v[172:175], a[100:103], a[16:31]
  ds_read_b128 a[100:103], v22 offset:16
  v_mov_b32_dpp v232, v68 row_ror:8 row_mask:0xf bank_mask:0xf
  v_perm_b32 v129, v232, v68, v6
  v_permlane16_swap_b32 v136, v140
  v_mov_b32_dpp v233, v69 row_ror:8 row_mask:0xf bank_mask:0xf
  v_mfma_f32_32x32x16_bf16 a[32:47], v[160:163], a[104:107], a[32:47]
  buffer_load_dwordx4 v[124:127], v5, s[36:39], s6 offen offset:2048
  v_perm_b32 v133, v233, v69, v6
  v_mov_b32_dpp v234, v70 row_ror:8 row_mask:0xf bank_mask:0xf
  v_perm_b32 v137, v234, v70, v6
  v_mov_b32_dpp v235, v71 row_ror:8 row_mask:0xf bank_mask:0xf
  v_mfma_f32_32x32x16_bf16 a[48:63], v[168:171], a[104:107], a[48:63]
  ds_read_b128 a[104:107], v30
  v_permlane16_swap_b32 v129, v133
  v_perm_b32 v141, v235, v71, v6
  s_waitcnt vmcnt(8)
  v_mov_b32_dpp v232, v72 row_ror:8 row_mask:0xf bank_mask:0xf
  v_perm_b32 v130, v232, v72, v6
  v_mfma_f32_32x32x16_bf16 a[32:47], v[164:167], a[108:111], a[32:47]
  v_permlane16_swap_b32 v137, v141
  v_mov_b32_dpp v233, v73 row_ror:8 row_mask:0xf bank_mask:0xf
  v_perm_b32 v134, v233, v73, v6
  v_mov_b32_dpp v234, v74 row_ror:8 row_mask:0xf bank_mask:0xf
  v_perm_b32 v138, v234, v74, v6
  v_mfma_f32_32x32x16_bf16 a[48:63], v[172:175], a[108:111], a[48:63]
  ds_read_b128 a[108:111], v30 offset:16
  s_mov_b32 s6, 622592
  buffer_load_dwordx4 v[144:147], v4, s[36:39], s6 offen
  v_mov_b32_dpp v235, v75 row_ror:8 row_mask:0xf bank_mask:0xf
  s_waitcnt lgkmcnt(4)
  v_mfma_f32_32x32x16_bf16 a[64:79], v[160:163], a[112:115], a[64:79]
  v_permlane16_swap_b32 v130, v134
  v_perm_b32 v142, v235, v75, v6
  v_mov_b32_dpp v232, v76 row_ror:8 row_mask:0xf bank_mask:0xf
  v_perm_b32 v131, v232, v76, v6
  v_mfma_f32_32x32x16_bf16 a[80:95], v[168:171], a[112:115], a[80:95]
  ds_read_b128 a[112:115], v38
  v_permlane16_swap_b32 v138, v142
  v_mov_b32_dpp v233, v77 row_ror:8 row_mask:0xf bank_mask:0xf
  v_perm_b32 v135, v233, v77, v6
  v_mov_b32_dpp v234, v78 row_ror:8 row_mask:0xf bank_mask:0xf
  v_mfma_f32_32x32x16_bf16 a[64:79], v[164:167], a[116:119], a[64:79]
  buffer_load_dwordx4 v[148:151], v4, s[36:39], s6 offen offset:2048
  v_perm_b32 v139, v234, v78, v6
  v_mov_b32_dpp v235, v79 row_ror:8 row_mask:0xf bank_mask:0xf
  v_permlane16_swap_b32 v131, v135
  v_perm_b32 v143, v235, v79, v6
  v_mfma_f32_32x32x16_bf16 a[80:95], v[172:175], a[116:119], a[80:95]
  ds_read_b128 a[116:119], v38 offset:16
  s_nop 1
  v_permlane16_swap_b32 v139, v143
  v_mfma_f32_32x32x16_bf16 v[176:191], v[160:163], a[120:123], v[176:191]
  v_mfma_f32_32x32x16_bf16 v[192:207], v[168:171], a[120:123], v[192:207]
  ds_read_b128 a[120:123], v46
  buffer_load_dwordx4 v[152:155], v5, s[36:39], s6 offen
  s_waitcnt vmcnt(9)
  v_mov_b32_dpp v232, v48 row_ror:8 row_mask:0xf bank_mask:0xf
  v_perm_b32 v64, v232, v48, v6
  v_mov_b32_dpp v233, v49 row_ror:8 row_mask:0xf bank_mask:0xf
  v_perm_b32 v68, v233, v49, v6
  v_mfma_f32_32x32x16_bf16 v[176:191], v[164:167], a[124:127], v[176:191]
  v_mov_b32_dpp v234, v50 row_ror:8 row_mask:0xf bank_mask:0xf
  v_perm_b32 v72, v234, v50, v6
  v_mov_b32_dpp v235, v51 row_ror:8 row_mask:0xf bank_mask:0xf
  v_permlane16_swap_b32 v64, v68
  v_perm_b32 v76, v235, v51, v6
  v_mfma_f32_32x32x16_bf16 v[192:207], v[172:175], a[124:127], v[192:207]
  ds_read_b128 a[124:127], v46 offset:16
  v_mov_b32_dpp v232, v52 row_ror:8 row_mask:0xf bank_mask:0xf
  v_perm_b32 v65, v232, v52, v6
  v_permlane16_swap_b32 v72, v76
  s_waitcnt lgkmcnt(4)
  v_mfma_f32_32x32x16_bf16 a[0:15], v[80:83], a[96:99], a[0:15]
  buffer_load_dwordx4 v[156:159], v5, s[36:39], s6 offen offset:2048
  v_lshrrev_b32 v243, 3, v239
  v_mul_u32_u24 v243, 26, v243
  v_and_b32 v243, -4, v243
  global_load_dwordx4 v[224:227], v243, s[8:9]
  global_load_dwordx3 v[228:230], v243, s[8:9] offset:16
  v_mfma_f32_32x32x16_bf16 a[16:31], v[88:91], a[96:99], a[16:31]
  ds_read_b128 a[96:99], v16
  v_mov_b32_dpp v233, v53 row_ror:8 row_mask:0xf bank_mask:0xf
  v_perm_b32 v69, v233, v53, v6
  v_mov_b32_dpp v234, v54 row_ror:8 row_mask:0xf bank_mask:0xf
  v_perm_b32 v73, v234, v54, v6
  v_mov_b32_dpp v235, v55 row_ror:8 row_mask:0xf bank_mask:0xf
  v_mfma_f32_32x32x16_bf16 a[0:15], v[84:87], a[100:103], a[0:15]
  v_permlane16_swap_b32 v65, v69
  v_perm_b32 v77, v235, v55, v6
  s_waitcnt vmcnt(10)
  v_mov_b32_dpp v232, v56 row_ror:8 row_mask:0xf bank_mask:0xf
  v_perm_b32 v66, v232, v56, v6
  v_mfma_f32_32x32x16_bf16 a[16:31], v[92:95], a[100:103], a[16:31]
  ds_read_b128 a[100:103], v16 offset:16
  s_mov_b32 s6, 753664
  buffer_load_dwordx4 v[160:163], v4, s[36:39], s6 offen
  v_permlane16_swap_b32 v73, v77
  v_mov_b32_dpp v233, v57 row_ror:8 row_mask:0xf bank_mask:0xf
  v_mfma_f32_32x32x16_bf16 a[32:47], v[80:83], a[104:107], a[32:47]
  v_perm_b32 v70, v233, v57, v6
  v_mov_b32_dpp v234, v58 row_ror:8 row_mask:0xf bank_mask:0xf
  v_perm_b32 v74, v234, v58, v6
  v_mov_b32_dpp v235, v59 row_ror:8 row_mask:0xf bank_mask:0xf
  v_permlane16_swap_b32 v66, v70
  v_mfma_f32_32x32x16_bf16 a[48:63], v[88:91], a[104:107], a[48:63]
  ds_read_b128 a[104:107], v24
  v_perm_b32 v78, v235, v59, v6
  v_mov_b32_dpp v232, v60 row_ror:8 row_mask:0xf bank_mask:0xf
  v_perm_b32 v67, v232, v60, v6
  v_permlane16_swap_b32 v74, v78
  v_mfma_f32_32x32x16_bf16 a[32:47], v[84:87], a[108:111], a[32:47]
  buffer_load_dwordx4 v[164:167], v4, s[36:39], s6 offen offset:2048
  v_mov_b32_dpp v233, v61 row_ror:8 row_mask:0xf bank_mask:0xf
  v_perm_b32 v71, v233, v61, v6
  v_mov_b32_dpp v234, v62 row_ror:8 row_mask:0xf bank_mask:0xf
  v_perm_b32 v75, v234, v62, v6
  v_mov_b32_dpp v235, v63 row_ror:8 row_mask:0xf bank_mask:0xf
  v_mfma_f32_32x32x16_bf16 a[48:63], v[92:95], a[108:111], a[48:63]
  ds_read_b128 a[108:111], v24 offset:16
  v_permlane16_swap_b32 v67, v71
  v_perm_b32 v79, v235, v63, v6
  s_waitcnt lgkmcnt(4)
  v_mfma_f32_32x32x16_bf16 a[64:79], v[80:83], a[112:115], a[64:79]
  s_nop 1
  v_permlane16_swap_b32 v75, v79
  v_mfma_f32_32x32x16_bf16 a[80:95], v[88:91], a[112:115], a[80:95]
  ds_read_b128 a[112:115], v32
  buffer_load_dwordx4 v[168:171], v5, s[36:39], s6 offen
  s_waitcnt vmcnt(11)
  v_mov_b32_dpp v232, v112 row_ror:8 row_mask:0xf bank_mask:0xf
  v_perm_b32 v48, v232, v112, v6
  v_mov_b32_dpp v233, v113 row_ror:8 row_mask:0xf bank_mask:0xf
  v_perm_b32 v52, v233, v113, v6
  v_mfma_f32_32x32x16_bf16 a[64:79], v[84:87], a[116:119], a[64:79]
  v_mov_b32_dpp v234, v114 row_ror:8 row_mask:0xf bank_mask:0xf
  v_perm_b32 v56, v234, v114, v6
  v_mov_b32_dpp v235, v115 row_ror:8 row_mask:0xf bank_mask:0xf
  v_permlane16_swap_b32 v48, v52
  v_perm_b32 v60, v235, v115, v6
  v_mfma_f32_32x32x16_bf16 a[80:95], v[92:95], a[116:119], a[80:95]
  ds_read_b128 a[116:119], v32 offset:16
  v_mov_b32_dpp v232, v116 row_ror:8 row_mask:0xf bank_mask:0xf
  v_perm_b32 v49, v232, v116, v6
  v_permlane16_swap_b32 v56, v60
  v_mov_b32_dpp v233, v117 row_ror:8 row_mask:0xf bank_mask:0xf
  v_mfma_f32_32x32x16_bf16 v[176:191], v[80:83], a[120:123], v[176:191]
  buffer_load_dwordx4 v[172:175], v5, s[36:39], s6 offen offset:2048
  v_perm_b32 v53, v233, v117, v6
  v_mov_b32_dpp v234, v118 row_ror:8 row_mask:0xf bank_mask:0xf
  v_perm_b32 v57, v234, v118, v6
  v_mov_b32_dpp v235, v119 row_ror:8 row_mask:0xf bank_mask:0xf
  v_mfma_f32_32x32x16_bf16 v[192:207], v[88:91], a[120:123], v[192:207]
  ds_read_b128 a[120:123], v40
  v_permlane16_swap_b32 v49, v53
  v_perm_b32 v61, v235, v119, v6
  s_waitcnt vmcnt(10)
  v_mov_b32_dpp v232, v120 row_ror:8 row_mask:0xf bank_mask:0xf
  v_perm_b32 v50, v232, v120, v6
  v_mfma_f32_32x32x16_bf16 v[176:191], v[84:87], a[124:127], v[176:191]
  v_permlane16_swap_b32 v57, v61
  v_mov_b32_dpp v233, v121 row_ror:8 row_mask:0xf bank_mask:0xf
  v_perm_b32 v54, v233, v121, v6
  v_mov_b32_dpp v234, v122 row_ror:8 row_mask:0xf bank_mask:0xf
  v_perm_b32 v58, v234, v122, v6
  v_mfma_f32_32x32x16_bf16 v[192:207], v[92:95], a[124:127], v[192:207]
  ds_read_b128 a[124:127], v40 offset:16
  v_mov_b32_dpp v235, v123 row_ror:8 row_mask:0xf bank_mask:0xf
  v_permlane16_swap_b32 v50, v54
  v_perm_b32 v62, v235, v123, v6
  s_waitcnt lgkmcnt(4)
  v_mfma_f32_32x32x16_bf16 a[0:15], v[96:99], a[96:99], a[0:15]
  v_mov_b32_dpp v232, v124 row_ror:8 row_mask:0xf bank_mask:0xf
  v_perm_b32 v51, v232, v124, v6
  v_permlane16_swap_b32 v58, v62
  v_mov_b32_dpp v233, v125 row_ror:8 row_mask:0xf bank_mask:0xf
  v_perm_b32 v55, v233, v125, v6
  v_mfma_f32_32x32x16_bf16 a[16:31], v[104:107], a[96:99], a[16:31]
  ds_read_b128 a[96:99], v17
  v_mov_b32_dpp v234, v126 row_ror:8 row_mask:0xf bank_mask:0xf
  v_perm_b32 v59, v234, v126, v6
  v_mov_b32_dpp v235, v127 row_ror:8 row_mask:0xf bank_mask:0xf
  v_permlane16_swap_b32 v51, v55
  v_mfma_f32_32x32x16_bf16 a[0:15], v[100:103], a[100:103], a[0:15]
  global_load_dwordx4 v[208:211], v7, s[18:19]
  v_perm_b32 v63, v235, v127, v6
  s_nop 1
  v_permlane16_swap_b32 v59, v63
  v_mfma_f32_32x32x16_bf16 a[16:31], v[108:111], a[100:103], a[16:31]
  ds_read_b128 a[100:103], v17 offset:16
  v_mfma_f32_32x32x16_bf16 a[32:47], v[96:99], a[104:107], a[32:47]
  v_mfma_f32_32x32x16_bf16 a[48:63], v[104:107], a[104:107], a[48:63]
  ds_read_b128 a[104:107], v25
  s_waitcnt vmcnt(9)
  v_mov_b32_dpp v232, v144 row_ror:8 row_mask:0xf bank_mask:0xf
  v_perm_b32 v80, v232, v144, v6
  v_mov_b32_dpp v233, v145 row_ror:8 row_mask:0xf bank_mask:0xf
  v_perm_b32 v84, v233, v145, v6
  v_mov_b32_dpp v234, v146 row_ror:8 row_mask:0xf bank_mask:0xf
  v_mfma_f32_32x32x16_bf16 a[32:47], v[100:103], a[108:111], a[32:47]
  global_load_dwordx4 v[212:215], v7, s[18:19] offset:16
  v_perm_b32 v88, v234, v146, v6
  v_mov_b32_dpp v235, v147 row_ror:8 row_mask:0xf bank_mask:0xf
  v_permlane16_swap_b32 v80, v84
  v_perm_b32 v92, v235, v147, v6
  v_mfma_f32_32x32x16_bf16 a[48:63], v[108:111], a[108:111], a[48:63]
  ds_read_b128 a[108:111], v25 offset:16
  v_mov_b32_dpp v232, v148 row_ror:8 row_mask:0xf bank_mask:0xf
  v_perm_b32 v81, v232, v148, v6
  v_permlane16_swap_b32 v88, v92
  s_waitcnt lgkmcnt(4)
  v_mfma_f32_32x32x16_bf16 a[64:79], v[96:99], a[112:115], a[64:79]
  v_mov_b32_dpp v233, v149 row_ror:8 row_mask:0xf bank_mask:0xf
  v_perm_b32 v85, v233, v149, v6
  v_mov_b32_dpp v234, v150 row_ror:8 row_mask:0xf bank_mask:0xf
  v_perm_b32 v89, v234, v150, v6
  v_mov_b32_dpp v235, v151 row_ror:8 row_mask:0xf bank_mask:0xf
  v_mfma_f32_32x32x16_bf16 a[80:95], v[104:107], a[112:115], a[80:95]
  ds_read_b128 a[112:115], v33
  v_permlane16_swap_b32 v81, v85
  v_perm_b32 v93, v235, v151, v6
  s_waitcnt vmcnt(8)
  v_mov_b32_dpp v232, v152 row_ror:8 row_mask:0xf bank_mask:0xf
  v_perm_b32 v82, v232, v152, v6
  v_mfma_f32_32x32x16_bf16 a[64:79], v[100:103], a[116:119], a[64:79]
  global_load_dwordx4 v[216:219], v7, s[18:19] offset:32
  v_permlane16_swap_b32 v89, v93
  v_mov_b32_dpp v233, v153 row_ror:8 row_mask:0xf bank_mask:0xf
  v_perm_b32 v86, v233, v153, v6
  v_mov_b32_dpp v234, v154 row_ror:8 row_mask:0xf bank_mask:0xf
  v_mfma_f32_32x32x16_bf16 a[80:95], v[108:111], a[116:119], a[80:95]
  ds_read_b128 a[116:119], v33 offset:16
  v_perm_b32 v90, v234, v154, v6
  v_mov_b32_dpp v235, v155 row_ror:8 row_mask:0xf bank_mask:0xf
  v_permlane16_swap_b32 v82, v86
  v_perm_b32 v94, v235, v155, v6
  v_mfma_f32_32x32x16_bf16 v[176:191], v[96:99], a[120:123], v[176:191]
  v_mov_b32_dpp v232, v156 row_ror:8 row_mask:0xf bank_mask:0xf
  v_perm_b32 v83, v232, v156, v6
  v_permlane16_swap_b32 v90, v94
  v_mov_b32_dpp v233, v157 row_ror:8 row_mask:0xf bank_mask:0xf
  v_perm_b32 v87, v233, v157, v6
  v_mfma_f32_32x32x16_bf16 v[192:207], v[104:107], a[120:123], v[192:207]
  ds_read_b128 a[120:123], v41
  v_mov_b32_dpp v234, v158 row_ror:8 row_mask:0xf bank_mask:0xf
  v_perm_b32 v91, v234, v158, v6
  v_mov_b32_dpp v235, v159 row_ror:8 row_mask:0xf bank_mask:0xf
  v_permlane16_swap_b32 v83, v87
  v_mfma_f32_32x32x16_bf16 v[176:191], v[100:103], a[124:127], v[176:191]
  global_load_dwordx4 v[220:223], v7, s[18:19] offset:48
  v_perm_b32 v95, v235, v159, v6
  s_nop 1
  v_permlane16_swap_b32 v91, v95
  v_mfma_f32_32x32x16_bf16 v[192:207], v[108:111], a[124:127], v[192:207]
  ds_read_b128 a[124:127], v41 offset:16
  s_waitcnt lgkmcnt(4)
  s_barrier
  v_mfma_f32_32x32x16_bf16 a[0:15], v[128:131], a[96:99], a[0:15]
  v_mfma_f32_32x32x16_bf16 a[16:31], v[136:139], a[96:99], a[16:31]
  ds_read_b128 a[128:131], v18
  s_waitcnt vmcnt(6)
  v_mov_b32_dpp v232, v160 row_ror:8 row_mask:0xf bank_mask:0xf
  v_perm_b32 v112, v232, v160, v6
  v_mov_b32_dpp v233, v161 row_ror:8 row_mask:0xf bank_mask:0xf
  v_perm_b32 v116, v233, v161, v6
  v_mfma_f32_32x32x16_bf16 a[0:15], v[132:135], a[100:103], a[0:15]
  v_mov_b32_dpp v234, v162 row_ror:8 row_mask:0xf bank_mask:0xf
  v_perm_b32 v120, v234, v162, v6
  v_mov_b32_dpp v235, v163 row_ror:8 row_mask:0xf bank_mask:0xf
  v_permlane16_swap_b32 v112, v116
  v_mfma_f32_32x32x16_bf16 a[16:31], v[140:143], a[100:103], a[16:31]
  ds_read_b128 a[132:135], v18 offset:16
  v_perm_b32 v124, v235, v163, v6
  v_mov_b32_dpp v232, v164 row_ror:8 row_mask:0xf bank_mask:0xf
  v_perm_b32 v113, v232, v164, v6
  v_mfma_f32_32x32x16_bf16 a[32:47], v[128:131], a[104:107], a[32:47]
  v_permlane16_swap_b32 v120, v124
  v_mov_b32_dpp v233, v165 row_ror:8 row_mask:0xf bank_mask:0xf
  v_perm_b32 v117, v233, v165, v6
  v_mov_b32_dpp v234, v166 row_ror:8 row_mask:0xf bank_mask:0xf
  v_mfma_f32_32x32x16_bf16 a[48:63], v[136:139], a[104:107], a[48:63]
  ds_read_b128 a[136:139], v19
  v_perm_b32 v121, v234, v166, v6
  v_mov_b32_dpp v235, v167 row_ror:8 row_mask:0xf bank_mask:0xf
  v_permlane16_swap_b32 v113, v117
  v_mfma_f32_32x32x16_bf16 a[32:47], v[132:135], a[108:111], a[32:47]
  v_perm_b32 v125, v235, v167, v6
  s_waitcnt vmcnt(4)
  v_mov_b32_dpp v232, v168 row_ror:8 row_mask:0xf bank_mask:0xf
  v_perm_b32 v114, v232, v168, v6
  v_permlane16_swap_b32 v121, v125
  v_mfma_f32_32x32x16_bf16 a[48:63], v[140:143], a[108:111], a[48:63]
  ds_read_b128 a[140:143], v19 offset:16
  v_mov_b32_dpp v233, v169 row_ror:8 row_mask:0xf bank_mask:0xf
  v_perm_b32 v118, v233, v169, v6
  v_mov_b32_dpp v234, v170 row_ror:8 row_mask:0xf bank_mask:0xf
  s_waitcnt lgkmcnt(4)
  v_mfma_f32_32x32x16_bf16 a[64:79], v[128:131], a[112:115], a[64:79]
  v_perm_b32 v122, v234, v170, v6
  v_mov_b32_dpp v235, v171 row_ror:8 row_mask:0xf bank_mask:0xf
  v_permlane16_swap_b32 v114, v118
  v_perm_b32 v126, v235, v171, v6
  v_mfma_f32_32x32x16_bf16 a[80:95], v[136:139], a[112:115], a[80:95]
  ds_read_b128 a[144:147], v20
  v_mov_b32_dpp v232, v172 row_ror:8 row_mask:0xf bank_mask:0xf
  v_perm_b32 v115, v232, v172, v6
  v_permlane16_swap_b32 v122, v126
  v_mfma_f32_32x32x16_bf16 a[64:79], v[132:135], a[116:119], a[64:79]
  v_mov_b32_dpp v233, v173 row_ror:8 row_mask:0xf bank_mask:0xf
  v_perm_b32 v119, v233, v173, v6
  v_mov_b32_dpp v234, v174 row_ror:8 row_mask:0xf bank_mask:0xf
  v_perm_b32 v123, v234, v174, v6
  v_mov_b32_dpp v235, v175 row_ror:8 row_mask:0xf bank_mask:0xf
  v_mfma_f32_32x32x16_bf16 a[80:95], v[140:143], a[116:119], a[80:95]
  ds_read_b128 a[148:151], v20 offset:16
  v_permlane16_swap_b32 v115, v119
  v_perm_b32 v127, v235, v175, v6
  v_mfma_f32_32x32x16_bf16 v[176:191], v[128:131], a[120:123], v[176:191]
  s_nop 1
  v_permlane16_swap_b32 v123, v127
  v_mfma_f32_32x32x16_bf16 v[192:207], v[136:139], a[120:123], v[192:207]
  ds_read_b128 a[152:155], v21
  v_mfma_f32_32x32x16_bf16 v[176:191], v[132:135], a[124:127], v[176:191]
  v_mfma_f32_32x32x16_bf16 v[192:207], v[140:143], a[124:127], v[192:207]
  ds_read_b128 a[156:159], v21 offset:16
  s_waitcnt lgkmcnt(4)
  v_mfma_f32_32x32x16_bf16 a[0:15], v[64:67], a[128:131], a[0:15]
  ds_read_b128 a[96:99], v26
  v_and_b32 v250, 1, v1
  v_lshlrev_b32 v250, 4, v250
  s_lshl_b32 s43, s71, 16
  v_mfma_f32_32x32x16_bf16 a[0:15], v[68:71], a[132:135], a[0:15]
  s_lshl_b32 s44, s72, 16
  v_mov_b32 v237, s43
  v_add_f32 v237, s44, v237
  s_and_b32 s70, s70, 0xffff
  v_mfma_f32_32x32x16_bf16 a[0:15], v[48:51], a[136:139], a[0:15]
  ds_read_b128 a[100:103], v26 offset:16
  v_alignbit_b32 v224, v225, v224, v250
  v_alignbit_b32 v225, v226, v225, v250
  v_alignbit_b32 v226, v227, v226, v250
  v_mfma_f32_32x32x16_bf16 a[0:15], v[52:55], a[140:143], a[0:15]
  v_alignbit_b32 v227, v228, v227, v250
  v_alignbit_b32 v228, v229, v228, v250
  v_alignbit_b32 v229, v230, v229, v250
  s_waitcnt lgkmcnt(2)
  v_mfma_f32_32x32x16_bf16 a[0:15], v[80:83], a[144:147], a[0:15]
  ds_read_b128 a[104:107], v27
  v_bfe_u32 v230, v230, v250, 16
  v_mfma_f32_32x32x16_bf16 a[0:15], v[84:87], a[148:151], a[0:15]
  v_dot2_f32_bf16 v237, v224, s64, v237
  v_mfma_f32_32x32x16_bf16 a[0:15], v[112:115], a[152:155], a[0:15]
  ds_read_b128 a[108:111], v27 offset:16
  v_dot2_f32_bf16 v237, v225, s65, v237
  v_mfma_f32_32x32x16_bf16 a[0:15], v[116:119], a[156:159], a[0:15]
  v_dot2_f32_bf16 v237, v226, s66, v237
  v_mfma_f32_32x32x16_bf16 a[16:31], v[72:75], a[128:131], a[16:31]
  ds_read_b128 a[112:115], v28
  v_dot2_f32_bf16 v237, v227, s67, v237
  v_mfma_f32_32x32x16_bf16 a[16:31], v[76:79], a[132:135], a[16:31]
  ds_write_b128 v12, a[0:3]
  v_mfma_f32_32x32x16_bf16 a[16:31], v[56:59], a[136:139], a[16:31]
  ds_read_b128 a[116:119], v28 offset:16
  v_dot2_f32_bf16 v237, v228, s68, v237
  v_mfma_f32_32x32x16_bf16 a[16:31], v[60:63], a[140:143], a[16:31]
  ds_write_b128 v12, a[4:7] offset:1024
  v_mfma_f32_32x32x16_bf16 a[16:31], v[88:91], a[144:147], a[16:31]
  ds_read_b128 a[120:123], v29
  v_dot2_f32_bf16 v237, v229, s69, v237
  v_mfma_f32_32x32x16_bf16 a[16:31], v[92:95], a[148:151], a[16:31]
  ds_write_b128 v12, a[8:11] offset:2048
  v_mfma_f32_32x32x16_bf16 a[16:31], v[120:123], a[152:155], a[16:31]
  ds_read_b128 a[124:127], v29 offset:16
  v_dot2_f32_bf16 v237, v230, s70, v237
  v_mfma_f32_32x32x16_bf16 a[16:31], v[124:127], a[156:159], a[16:31]
  ds_write_b128 v12, a[12:15] offset:3072
  s_waitcnt lgkmcnt(8)
  v_mfma_f32_32x32x16_bf16 a[32:47], v[64:67], a[96:99], a[32:47]
  ds_read_b128 a[128:131], v34
  v_mfma_f32_32x32x16_bf16 a[32:47], v[68:71], a[100:103], a[32:47]
  ds_write_b128 v12, a[16:19] offset:4096
  v_mfma_f32_32x32x16_bf16 a[32:47], v[48:51], a[104:107], a[32:47]
  ds_read_b128 a[132:135], v34 offset:16
  v_mfma_f32_32x32x16_bf16 a[32:47], v[52:55], a[108:111], a[32:47]
  s_lshl_b32 s43, s5, 2
  v_mov_b32 v244, s43
  global_load_dword v238, v244, s[24:25] offset:128 sc1
  ds_write_b128 v12, a[20:23] offset:5120
  s_waitcnt lgkmcnt(5)
  v_mfma_f32_32x32x16_bf16 a[32:47], v[80:83], a[112:115], a[32:47]
  ds_read_b128 a[136:139], v35
  v_mfma_f32_32x32x16_bf16 a[32:47], v[84:87], a[116:119], a[32:47]
  ds_write_b128 v12, a[24:27] offset:6144
  v_mfma_f32_32x32x16_bf16 a[32:47], v[112:115], a[120:123], a[32:47]
  ds_read_b128 a[140:143], v35 offset:16
  v_and_b32 v249, s53, v237
  v_mfma_f32_32x32x16_bf16 a[32:47], v[116:119], a[124:127], a[32:47]
  v_mul_f32 v249, 0.5, v249
  v_mov_b32 v245, 0
  ds_write_b128 v12, a[28:31] offset:7168
  v_mfma_f32_32x32x16_bf16 a[48:63], v[72:75], a[96:99], a[48:63]
  ds_read_b128 a[144:147], v36
  v_mfma_f32_32x32x16_bf16 a[48:63], v[76:79], a[100:103], a[48:63]
  ds_write_b128 v13, a[32:35]
  s_waitcnt lgkmcnt(2)
  s_barrier
  v_mfma_f32_32x32x16_bf16 a[48:63], v[56:59], a[104:107], a[48:63]
  ds_read_b128 a[148:151], v36 offset:16
  ds_read_b128 v[96:99], v15
  v_mfma_f32_32x32x16_bf16 a[48:63], v[60:63], a[108:111], a[48:63]
  ds_write_b128 v13, a[36:39] offset:1024
  ds_read_b128 v[100:103], v15 offset:1024
  v_mfma_f32_32x32x16_bf16 a[48:63], v[88:91], a[112:115], a[48:63]
  ds_read_b128 a[152:155], v37
  ds_read_b128 v[104:107], v15 offset:2048
  v_mfma_f32_32x32x16_bf16 a[48:63], v[92:95], a[116:119], a[48:63]
  ds_write_b128 v13, a[40:43] offset:2048
  ds_read_b128 v[108:111], v15 offset:3072
  v_mfma_f32_32x32x16_bf16 a[48:63], v[120:123], a[120:123], a[48:63]
  ds_read_b128 a[156:159], v37 offset:16
  ds_read_b128 v[144:147], v15 offset:4096
  v_mfma_f32_32x32x16_bf16 a[48:63], v[124:127], a[124:127], a[48:63]
  ds_write_b128 v13, a[44:47] offset:3072
  ds_read_b128 v[148:151], v15 offset:5120
  s_waitcnt lgkmcnt(8)
  v_add_f32 v176, v176, v96
  v_add_f32 v177, v177, v97
  v_mfma_f32_32x32x16_bf16 a[80:95], v[72:75], a[128:131], a[80:95]
  ds_read_b128 a[96:99], v42
  ds_read_b128 v[152:155], v15 offset:6144
  v_add_f32 v178, v178, v98
  v_add_f32 v179, v179, v99
  v_add_f32 v180, v180, v100
  v_add_f32 v181, v181, v101
  v_add_f32 v182, v182, v102
  v_mfma_f32_32x32x16_bf16 a[80:95], v[76:79], a[132:135], a[80:95]
  ds_write_b128 v13, a[48:51] offset:4096
  ds_read_b128 v[156:159], v15 offset:7168
  s_waitcnt lgkmcnt(5)
  s_barrier
  v_mfma_f32_32x32x16_bf16 a[80:95], v[56:59], a[136:139], a[80:95]
  ds_read_b128 a[100:103], v42 offset:16
  v_add_f32 v183, v183, v103
  v_add_f32 v184, v184, v104
  v_add_f32 v185, v185, v105
  v_add_f32 v186, v186, v106
  v_add_f32 v187, v187, v107
  v_add_f32 v188, v188, v108
  v_mfma_f32_32x32x16_bf16 a[80:95], v[60:63], a[140:143], a[80:95]
  ds_write_b128 v13, a[52:55] offset:5120
  v_add_f32 v189, v189, v109
  v_add_f32 v190, v190, v110
  v_add_f32 v191, v191, v111
  v_mfma_f32_32x32x16_bf16 a[80:95], v[88:91], a[144:147], a[80:95]
  ds_read_b128 a[104:107], v43
  ds_read_b128 v[96:99], v15 offset:32768
  s_waitcnt lgkmcnt(8)
  v_add_f32 v192, v192, v144
  v_add_f32 v193, v193, v145
  v_add_f32 v194, v194, v146
  v_add_f32 v195, v195, v147
  v_add_f32 v196, v196, v148
  v_mfma_f32_32x32x16_bf16 a[80:95], v[92:95], a[148:151], a[80:95]
  ds_write_b128 v13, a[56:59] offset:6144
  ds_read_b128 v[100:103], v15 offset:33792
  v_add_f32 v197, v197, v149
  v_add_f32 v198, v198, v150
  v_mfma_f32_32x32x16_bf16 a[80:95], v[120:123], a[152:155], a[80:95]
  ds_read_b128 a[108:111], v43 offset:16
  ds_read_b128 v[104:107], v15 offset:34816
  v_add_f32 v199, v199, v151
  s_waitcnt lgkmcnt(8)
  v_add_f32 v200, v200, v152
  v_add_f32 v201, v201, v153
  v_add_f32 v202, v202, v154
  v_add_f32 v203, v203, v155
  v_mfma_f32_32x32x16_bf16 a[80:95], v[124:127], a[156:159], a[80:95]
  ds_write_b128 v13, a[60:63] offset:7168
  ds_read_b128 v[108:111], v15 offset:35840
  v_add_f32 v204, v204, v156
  v_add_f32 v205, v205, v157
  v_mfma_f32_32x32x16_bf16 a[64:79], v[64:67], a[128:131], a[64:79]
  ds_read_b128 a[112:115], v44
  v_add_f32 v206, v206, v158
  v_add_f32 v207, v207, v159
  v_mfma_f32_32x32x16_bf16 a[64:79], v[68:71], a[132:135], a[64:79]
  ds_write_b128 v14, a[80:83] offset:4096
  s_waitcnt lgkmcnt(6)
  v_add_f32 v176, v176, v96
  v_add_f32 v177, v177, v97
  s_waitcnt lgkmcnt(3)
  s_barrier
  v_mfma_f32_32x32x16_bf16 a[64:79], v[48:51], a[136:139], a[64:79]
  ds_read_b128 a[116:119], v44 offset:16
  ds_read_b128 v[144:147], v15 offset:36864
  ds_read_b128 v[148:151], v15 offset:37888
  v_add_f32 v178, v178, v98
  v_add_f32 v179, v179, v99
  v_add_f32 v180, v180, v100
  v_add_f32 v181, v181, v101
  v_add_f32 v182, v182, v102
  v_mfma_f32_32x32x16_bf16 a[64:79], v[52:55], a[140:143], a[64:79]
  ds_write_b128 v14, a[84:87] offset:5120
  ds_read_b128 v[152:155], v15 offset:38912
  ds_read_b128 v[156:159], v15 offset:39936
  v_add_f32 v183, v183, v103
  s_waitcnt lgkmcnt(8)
  v_add_f32 v184, v184, v104
  v_mfma_f32_32x32x16_bf16 a[64:79], v[80:83], a[144:147], a[64:79]
  ds_read_b128 a[120:123], v45
  v_add_f32 v185, v185, v105
  v_add_f32 v186, v186, v106
  v_add_f32 v187, v187, v107
  v_add_f32 v188, v188, v108
  v_add_f32 v189, v189, v109
  v_add_f32 v190, v190, v110
  v_add_f32 v191, v191, v111
  v_mfma_f32_32x32x16_bf16 a[64:79], v[84:87], a[148:151], a[64:79]
  ds_write_b128 v14, a[88:91] offset:6144
  s_waitcnt lgkmcnt(5)
  v_add_f32 v192, v192, v144
  v_add_f32 v193, v193, v145
  v_add_f32 v194, v194, v146
  v_mfma_f32_32x32x16_bf16 a[64:79], v[112:115], a[152:155], a[64:79]
  ds_read_b128 a[124:127], v45 offset:16
  v_add_f32 v195, v195, v147
  v_add_f32 v196, v196, v148
  v_add_f32 v197, v197, v149
  v_add_f32 v198, v198, v150
  v_add_f32 v199, v199, v151
  s_waitcnt lgkmcnt(3)
  v_add_f32 v200, v200, v152
  v_mfma_f32_32x32x16_bf16 a[64:79], v[116:119], a[156:159], a[64:79]
  ds_write_b128 v14, a[92:95] offset:7168
  v_add_f32 v201, v201, v153
  v_add_f32 v202, v202, v154
  v_add_f32 v203, v203, v155
  v_mfma_f32_32x32x16_bf16 v[176:191], v[64:67], a[96:99], v[176:191]
  v_add_f32 v204, v204, v156
  v_add_f32 v205, v205, v157
  v_add_f32 v206, v206, v158
  v_add_f32 v207, v207, v159
  v_mfma_f32_32x32x16_bf16 v[176:191], v[68:71], a[100:103], v[176:191]
  ds_write_b128 v14, a[64:67]
  s_waitcnt lgkmcnt(1)
  s_barrier
  v_mfma_f32_32x32x16_bf16 v[176:191], v[48:51], a[104:107], v[176:191]
  ds_read_b128 v[144:147], v236 offset:4096
  ds_read_b128 v[148:151], v236 offset:5120
  v_mfma_f32_32x32x16_bf16 v[176:191], v[52:55], a[108:111], v[176:191]
  ds_write_b128 v14, a[68:71] offset:1024
  ds_read_b128 v[152:155], v236 offset:6144
  ds_read_b128 v[156:159], v236 offset:7168
  v_mfma_f32_32x32x16_bf16 v[176:191], v[80:83], a[112:115], v[176:191]
  v_mfma_f32_32x32x16_bf16 v[176:191], v[84:87], a[116:119], v[176:191]
  ds_write_b128 v14, a[72:75] offset:2048
  s_waitcnt lgkmcnt(4)
  v_add_f32 v192, v192, v144
  v_add_f32 v193, v193, v145
  v_add_f32 v194, v194, v146
  v_add_f32 v195, v195, v147
  v_mfma_f32_32x32x16_bf16 v[176:191], v[112:115], a[120:123], v[176:191]
  v_add_f32 v196, v196, v148
  v_add_f32 v197, v197, v149
  v_add_f32 v198, v198, v150
  v_add_f32 v199, v199, v151
  s_waitcnt lgkmcnt(1)
  v_add_f32 v200, v200, v152
  v_add_f32 v201, v201, v153
  v_add_f32 v202, v202, v154
  v_add_f32 v203, v203, v155
  v_mfma_f32_32x32x16_bf16 v[176:191], v[116:119], a[124:127], v[176:191]
  ds_write_b128 v14, a[76:79] offset:3072
  v_add_f32 v204, v204, v156
  v_add_f32 v205, v205, v157
  v_add_f32 v206, v206, v158
  v_add_f32 v207, v207, v159
  s_nop 1
  v_mfma_f32_32x32x16_bf16 v[192:207], v[72:75], a[96:99], v[192:207]
  v_mfma_f32_32x32x16_bf16 v[192:207], v[76:79], a[100:103], v[192:207]
  s_waitcnt vmcnt(0)
  v_readfirstlane_b32 s43, v238
  s_mov_b32 s44, 0x49000000
  s_mov_b32 s45, 0xc9000000
  s_waitcnt lgkmcnt(0)
  s_barrier
  v_mfma_f32_32x32x16_bf16 v[192:207], v[56:59], a[104:107], v[192:207]
  ds_read_b128 v[96:99], v236
  ds_read_b128 v[100:103], v236 offset:1024
  v_mfma_f32_32x32x16_bf16 v[192:207], v[60:63], a[108:111], v[192:207]
  ds_read_b128 v[104:107], v236 offset:2048
  ds_read_b128 v[108:111], v236 offset:3072
  v_mfma_f32_32x32x16_bf16 v[192:207], v[88:91], a[112:115], v[192:207]
  v_mfma_f32_32x32x16_bf16 v[192:207], v[92:95], a[116:119], v[192:207]
  s_waitcnt lgkmcnt(2)
  v_add_f32 v176, v176, v96
  v_add_f32 v177, v177, v97
  v_add_f32 v178, v178, v98
  v_add_f32 v179, v179, v99
  v_add_f32 v180, v180, v100
  v_add_f32 v181, v181, v101
  v_mfma_f32_32x32x16_bf16 v[192:207], v[120:123], a[120:123], v[192:207]
  v_add_f32 v182, v182, v102
  v_add_f32 v183, v183, v103
  s_waitcnt lgkmcnt(0)
  v_add_f32 v184, v184, v104
  v_add_f32 v185, v185, v105
  v_add_f32 v186, v186, v106
  v_add_f32 v187, v187, v107
  v_mfma_f32_32x32x16_bf16 v[192:207], v[124:127], a[124:127], v[192:207]
  v_add_f32 v188, v188, v108
  v_add_f32 v189, v189, v109
  v_add_f32 v190, v190, v110
  v_add_f32 v191, v191, v111
  v_cvt_pk_bf16_f32 v176, v176, v180
  v_cvt_pk_bf16_f32 v177, v177, v181
  v_cvt_pk_bf16_f32 v178, v178, v182
  v_cvt_pk_bf16_f32 v179, v179, v183
  v_cvt_pk_bf16_f32 v184, v184, v188
  v_cvt_pk_bf16_f32 v185, v185, v189
  v_cvt_pk_bf16_f32 v186, v186, v190
  v_cvt_pk_bf16_f32 v187, v187, v191
  v_pk_max_i16 v176, v176, 0
  v_pk_max_i16 v177, v177, 0
  v_pk_max_i16 v178, v178, 0
  v_pk_max_i16 v179, v179, 0
  v_pk_max_i16 v184, v184, 0
  v_pk_max_i16 v185, v185, 0
  v_pk_max_i16 v186, v186, 0
  v_pk_max_i16 v187, v187, 0
  v_dot2_f32_bf16 v245, v176, v208, v245
  v_dot2_f32_bf16 v249, v177, v212, v249
  v_dot2_f32_bf16 v245, v178, v216, v245
  v_dot2_f32_bf16 v249, v179, v220, v249
  v_dot2_f32_bf16 v245, v184, v209, v245
  v_dot2_f32_bf16 v249, v185, v213, v249
  v_dot2_f32_bf16 v245, v186, v217, v245
  v_dot2_f32_bf16 v249, v187, v221, v249
  v_cvt_pk_bf16_f32 v192, v192, v196
  v_cvt_pk_bf16_f32 v193, v193, v197
  v_cvt_pk_bf16_f32 v194, v194, v198
  v_cvt_pk_bf16_f32 v195, v195, v199
  v_cvt_pk_bf16_f32 v200, v200, v204
  v_cvt_pk_bf16_f32 v201, v201, v205
  v_cvt_pk_bf16_f32 v202, v202, v206
  v_cvt_pk_bf16_f32 v203, v203, v207
  v_pk_max_i16 v192, v192, 0
  v_pk_max_i16 v193, v193, 0
  v_pk_max_i16 v194, v194, 0
  v_pk_max_i16 v195, v195, 0
  v_pk_max_i16 v200, v200, 0
  v_pk_max_i16 v201, v201, 0
  v_pk_max_i16 v202, v202, 0
  v_pk_max_i16 v203, v203, 0
  v_dot2_f32_bf16 v245, v192, v210, v245
  v_dot2_f32_bf16 v249, v193, v214, v249
  v_dot2_f32_bf16 v245, v194, v218, v245
  v_dot2_f32_bf16 v249, v195, v222, v249
  v_dot2_f32_bf16 v245, v200, v211, v245
  v_dot2_f32_bf16 v249, v201, v215, v249
  v_dot2_f32_bf16 v245, v202, v219, v245
  v_dot2_f32_bf16 v249, v203, v223, v249
  s_cmp_eq_u32 s43, 0
  s_nop 1
  v_add_f32 v242, v249, v245
  v_add_f32 v243, v249, v245
  s_nop 1
  v_permlane32_swap_b32 v242, v243
  v_add_f32 v242, v242, v243
  v_min_f32 v242, s44, v242
  v_max_f32 v242, s45, v242
  v_floor_f32 v243, v242
  v_sub_f32 v244, v242, v243
  v_cvt_i32_f32 v233, v243
  v_mul_f32 v244, 0x4f800000, v244
  v_add_u32 v233, 0x1000000, v233
  v_cvt_u32_f32 v232, v244
  s_cbranch_scc1 L_SLOW
L_GO:
  s_mov_b32 exec_lo, -1
  s_mov_b32 exec_hi, 0
  global_atomic_add_x2 v[234:235], v239, v[232:233], s[26:27] sc0 sc1
  v_lshrrev_b32 v239, 2, v239
  s_waitcnt vmcnt(0)
  v_add_co_u32 v232, vcc, v232, v234
  v_add_u32 v242, 0x800000, v235
  v_lshrrev_b32 v242, 24, v242
  v_addc_co_u32 v233, vcc, v233, v235, vcc
  v_cmp_eq_u32 vcc, 7, v242
  v_cvt_f32_u32 v232, v232
  v_subrev_u32 v233, 0x8000000, v233
  v_cvt_f32_i32 v233, v233
  s_and_b64 exec, exec, vcc
  s_cbranch_execz L_FIN
  v_fmac_f32 v233, 0x2f800000, v232
  v_mul_f32 v233, 0xbfb8aa3b, v233
  v_exp_f32 v233, v233
  s_nop 0
  v_add_f32 v233, 1.0, v233
  v_rcp_f32 v233, v233
  s_nop 0
  v_cvt_pk_bf16_f32 v233, v233, v233
  global_store_short v239, v233, s[22:23]
L_FIN:
L_END:
  s_endpgm
L_SLOW:
  s_lshl_b32 s43, s5, 2
  v_mov_b32 v243, s43
  v_mov_b32 v241, 1
  s_mov_b64 exec, 1
  global_atomic_add v241, v243, v241, s[24:25] sc0 sc1
  s_waitcnt vmcnt(0)
  v_readfirstlane_b32 s43, v241
  s_cmp_lg_u32 s43, 0
  s_cbranch_scc1 L_SPIN
  s_mov_b64 exec, -1
  s_lshl_b32 s43, s5, 10
  v_lshlrev_b32 v244, 3, v1
  v_add_u32 v244, s43, v244
  global_atomic_swap_x2 v[224:225], v244, v[246:247], s[26:27] sc0 sc1
  global_atomic_swap_x2 v[226:227], v244, v[246:247], s[26:27] offset:512 sc0 sc1
  v_mov_b32 v244, 1
  s_waitcnt vmcnt(0)
  s_mov_b64 exec, 1
  global_store_dword v243, v244, s[24:25] offset:128 sc0 sc1
  s_branch L_GO
L_SPIN:
  global_atomic_or v241, v243, v246, s[24:25] offset:128 sc0 sc1
  s_waitcnt vmcnt(0)
  v_readfirstlane_b32 s43, v241
  s_cmp_lg_u32 s43, 0
  s_cbranch_scc1 L_GO
  s_sleep 8
  s_branch L_SPIN
.section .rodata,"a"
.p2align 6
.amdhsa_kernel standalone__deep_cross_wide_deep__recsys_kernel
  .amdhsa_next_free_vgpr 512
  .amdhsa_next_free_sgpr 102
  .amdhsa_accum_offset 256
  .amdhsa_group_segment_fixed_size 0
  .amdhsa_kernarg_size 96
  .amdhsa_user_sgpr_count 2
  .amdhsa_user_sgpr_kernarg_segment_ptr 1
  .amdhsa_system_sgpr_workgroup_id_x 1
.end_amdhsa_kernel
```
